```python
import torch

def _softmax(x, axis=-1):
    return torch.softmax(x, dim=axis)
def _gelu(x):
    return torch.nn.functional.gelu(x, approximate="tanh")
def _silu(x):
    return torch.nn.functional.silu(x)
def _sigmoid(x):
    return torch.sigmoid(x)
def _layernorm(x, axis=-1, eps=1e-5):
    m = x.mean(dim=axis, keepdim=True)
    v = x.var(dim=axis, keepdim=True, unbiased=False)
    return (x - m) / torch.sqrt(v + eps)
def _scatter_add(tgt, idx, src, axis=0):
    return tgt.clone().index_add_(axis, idx, src)
def _segment_sum(src, seg, n):
    out = torch.zeros((n,) + src.shape[1:], dtype=src.dtype)
    return out.index_add_(0, seg, src)
def _pad(x, pw):
    flat = tuple(v for pair in reversed(pw) for v in pair)
    return torch.nn.functional.pad(x, flat)

kernel_name = 'sequential_preLN__sliding_block__glu_gated_reglu__prompt'

def setup_inputs():

    _w = (lambda a: (lambda t: t.to(torch.bfloat16) if t.is_floating_point() else t)(torch.as_tensor(a)))
    def _A_setup():
        B, S, D = 1, 2048, 512
        return {
            "x": _w((lambda *s: torch.randn(*s, dtype=torch.bfloat16) * 0.05)(B, S, D)),
            "wqkv": _w((lambda *s: torch.randn(*s, dtype=torch.bfloat16) * 0.05)(D, 3 * D)),
            "wo": _w((lambda *s: torch.randn(*s, dtype=torch.bfloat16) * 0.05)(D, D)),
        }
    _A_in = _A_setup()

    def _B_setup():
        B, S, D, F = 1, 2048, 512, 1792
        return {
            "x": _w((lambda *s: torch.randn(*s, dtype=torch.bfloat16) * 0.05)(B, S, D)),
            "W_gate": _w((lambda *s: torch.randn(*s, dtype=torch.bfloat16) * 0.8)(D, F) * (2.0 / D) ** 0.5),
            "W_up": _w((lambda *s: torch.randn(*s, dtype=torch.bfloat16) * 0.8)(D, F) * (2.0 / D) ** 0.5),
            "W_down": _w((lambda *s: torch.randn(*s, dtype=torch.bfloat16) * 0.8)(F, D) * (1.0 / F) ** 0.5),
        }
    _B_in = _B_setup()

    return {
        "A_x": _A_in["x"],
        "A_wqkv": _A_in["wqkv"],
        "A_wo": _A_in["wo"],
        "B_x": _B_in["x"],
        "B_W_gate": _B_in["W_gate"],
        "B_W_up": _B_in["W_up"],
        "B_W_down": _B_in["W_down"],
    }

def reference(A_x, A_wqkv, A_wo, B_x, B_W_gate, B_W_up, B_W_down):
    def _A_ref(x, wqkv, wo):
        B, S, D = x.shape
        H = 32; Dh = D // H; W = 256
        qkv = (lambda x, *d: x.permute(*d))((x @ wqkv).reshape(B, S, 3, H, Dh), 2, 0, 3, 1, 4)
        q, k, v = qkv[0], qkv[1], qkv[2]
        scores = torch.einsum("bhqd,bhkd->bhqk", q, k) * (Dh ** -0.5)
        idx = torch.arange(S)
        mask = (idx[:, None] - idx[None, :] >= 0) & (idx[:, None] - idx[None, :] < W)
        scores = torch.where(mask[None, None], scores, -1e9)
        p = _softmax(scores, axis=-1)
        o = torch.einsum("bhqk,bhkd->bhqd", p, v)
        return (lambda x, *d: x.permute(*d))(o, 0, 2, 1, 3).reshape(B, S, D) @ wo

    def _B_ref(x, W_gate, W_up, W_down):
        gate = torch.einsum("bsd,df->bsf", x, W_gate)
        up = torch.einsum("bsd,df->bsf", x, W_up)
        gate = gate * (lambda x, dt: x.to(dt))(gate > 0, gate.dtype)
        h = gate * up
        return torch.einsum("bsf,fd->bsd", h, W_down)

    x = A_x
    h = x + _A_ref(_layernorm(x, axis=-1), A_wqkv, A_wo)
    h2 = h + _B_ref(_layernorm(h, axis=-1), B_W_gate, B_W_up, B_W_down)
    return h2
```

```asm
; @launch grid=(256,1,1) block=(256,1,1) lds=163840
.amdgcn_target "amdgcn-amd-amdhsa--gfx950"
.text
.globl sequential_preLN__sliding_block__glu_gated_reglu__prompt_kernel
.p2align 8
.type sequential_preLN__sliding_block__glu_gated_reglu__prompt_kernel,@function
sequential_preLN__sliding_block__glu_gated_reglu__prompt_kernel:
    s_cmp_ge_u32 s2, 256
    s_cbranch_scc1 L_end
    s_load_dwordx16 s[64:79], s[0:1], 0
    s_load_dwordx4 s[80:83], s[0:1], 64
    s_getpc_b64 s[62:63]
L_pc:
    v_lshrrev_b32 v4, 6, v0
    s_lshr_b32 s42, s2, 1
    s_and_b32 s42, s42, 124
    v_add_u32 v4, s42, v4
    v_mul_u32_u24 v4, 4, v4
    v_and_b32 v5, 63, v0
    v_add_lshl_u32 v4, v4, v5, 7
    v_min_u32 v4, L_fin-L_pc-4, v4
    s_mov_b64 exec, 15
    global_load_dword v253, v4, s[62:63]
    s_mov_b64 exec, -1
    v_lshrrev_b32 v5, 6, v0
    v_and_b32 v0, 63, v0
    v_readfirstlane_b32 s32, v5
    s_lshr_b32 s41, s2, 3
    s_bfe_u32 s43, s2, 0x20001
    s_and_b32 s44, s2, 1
    s_and_b32 s45, s41, 7
    s_lshr_b32 s46, s41, 3
    s_lshl3_add_u32 s35, s43, s45
    s_lshl2_add_u32 s36, s44, s46
    s_lshl1_add_u32 s42, s46, s45
    v_lshrrev_b32 v16, 3, v0
    v_and_b32 v17, 7, v0
    v_lshrrev_b32 v18, 4, v0
    v_xor_b32 v19, v17, v18
    v_lshlrev_b32 v19, 4, v19
    v_lshl_add_u32 v4, v16, 10, v19
    v_mul_u32_u24 v6, 3072, v16
    v_lshlrev_b32 v18, 2, v18
    v_and_b32 v18, 4, v18
    v_xor_b32 v18, v18, v17
    v_lshl_add_u32 v6, v18, 4, v6
    v_add_u32 v7, 96256, v6
    s_lshl2_add_u32 s45, s35, s32
    s_lshl_b32 s45, s45, 14
    v_add_u32 v4, s45, v4
    v_xor_b32 v5, 64, v4
    v_add_u32 v5, 7168, v5
    s_lshl_b32 s84, s42, 7
    s_mul_i32 s46, s32, 192
    s_add_u32 s46, s46, s36
    s_lshl_b32 s46, s46, 7
    s_add_u32 s46, s46, 1024
    s_lshl_b32 s60, s32, 11
    s_lshl_b32 s61, s32, 12
    s_add_u32 s47, s42, 0
    s_and_b32 s47, s47, 7
    s_mul_i32 s92, s47, 196608
    s_add_u32 s92, s92, s46
    s_add_u32 s47, s42, 1
    s_and_b32 s47, s47, 7
    s_mul_i32 s93, s47, 196608
    s_add_u32 s93, s93, s46
    s_add_u32 s47, s42, 2
    s_and_b32 s47, s47, 7
    s_mul_i32 s94, s47, 196608
    s_add_u32 s94, s94, s46
    v_mov_b32 v2, 0
    s_mov_b32 s10, 2097152
    s_mov_b32 s11, 0x20000
    s_mov_b32 s14, 1572864
    s_mov_b32 s15, 0x20000
    s_waitcnt lgkmcnt(0)
    s_mov_b32 s8, s64
    s_and_b32 s9, s65, 0xffff
    s_mov_b32 s12, s66
    s_and_b32 s13, s67, 0xffff
    s_add_u32 m0, s60, 0
    s_and_b32 s84, s84, 0x380
    buffer_load_dwordx4 v4, s[8:11], s84 offen  lds
    buffer_load_dwordx4 v5, s[8:11], s84 offen offset:1024  lds
    s_add_u32 m0, s61, 65536
    s_nop 0
    buffer_load_dwordx4 v6, s[12:15], s92 offen  lds
    buffer_load_dwordx4 v7, s[12:15], s92 offen offset:2048  lds
    s_add_u32 s84, s84, 128
    s_add_u32 m0, s60, 8192
    s_and_b32 s84, s84, 0x380
    buffer_load_dwordx4 v4, s[8:11], s84 offen  lds
    buffer_load_dwordx4 v5, s[8:11], s84 offen offset:1024  lds
    s_add_u32 m0, s61, 66560
    s_nop 0
    buffer_load_dwordx4 v6, s[12:15], s93 offen  lds
    buffer_load_dwordx4 v7, s[12:15], s93 offen offset:2048  lds
    s_mov_b32 s16, s82
    s_and_b32 s17, s83, 0xffff
    s_mov_b32 s18, 33554432
    s_mov_b32 s19, 0x20000
    s_cmp_lt_u32 s2, 41
    s_cselect_b32 s63, s32, 0
    s_cmp_lg_u32 s63, 3
    s_cbranch_scc1 nz_1
    v_mov_b32 v28, 0
    v_mov_b32 v29, 0
    v_mov_b32 v30, 0
    v_mov_b32 v31, 0
    v_lshlrev_b32 v19, 7, v0
    s_lshl_b32 s47, s2, 11
    s_mov_b64 exec, 0xffff
    buffer_store_dwordx4 v[28:31], v19, s[16:19], s47 offen sc1
    s_mov_b64 exec, -1
nz_1:
    s_add_u32 s47, s42, 3
    s_and_b32 s47, s47, 7
    s_mul_i32 s95, s47, 196608
    s_add_u32 s95, s95, s46
    s_add_u32 s47, s42, 4
    s_and_b32 s47, s47, 7
    s_mul_i32 s96, s47, 196608
    s_add_u32 s96, s96, s46
    s_add_u32 s47, s42, 5
    s_and_b32 s47, s47, 7
    s_mul_i32 s97, s47, 196608
    s_add_u32 s97, s97, s46
    s_add_u32 s47, s42, 6
    s_and_b32 s47, s47, 7
    s_mul_i32 s98, s47, 196608
    s_add_u32 s98, s98, s46
    s_add_u32 s47, s42, 7
    s_and_b32 s47, s47, 7
    s_mul_i32 s99, s47, 196608
    s_add_u32 s99, s99, s46
    v_lshlrev_b32 v1, 4, v0
    s_bfe_u32 s43, s2, 0x20001
    s_and_b32 s45, s41, 3
    s_lshl2_add_u32 s39, s43, s45
    s_lshl2_add_u32 s46, s44, s45
    s_lshl3_add_u32 s37, s43, s46
    s_lshr_b32 s38, s41, 2
    s_lshl3_add_u32 s40, s44, s38
    s_and_b32 s33, s32, 1
    s_lshr_b32 s34, s32, 1
    s_mov_b32 s48, 0
    s_mov_b32 s49, -1
    s_mov_b32 s58, 1
    s_mov_b32 s20, s76
    s_and_b32 s21, s77, 0xffff
    s_mov_b32 s22, 1835008
    s_mov_b32 s23, 0x20000
    s_mov_b64 s[76:77], s[78:79]
    s_cmp_lt_u32 s2, 224
    s_cbranch_scc0 t_2
    s_and_b32 s62, s2, 7
    s_mov_b32 s45, s41
    s_cmp_eq_u32 s33, 0
    s_cselect_b32 s24, s72, s74
    s_cselect_b32 s25, s73, s75
    s_mov_b32 s26, 1835008
    s_mov_b32 s51, 3584
    s_lshl1_add_u32 s52, s45, s34
    s_lshl_b32 s54, s52, 7
    s_lshl_b32 s52, s52, 16
    s_lshl_b32 s46, s33, 8
    s_add_u32 s52, s52, s46
    s_add_u32 s52, s52, 13631488
    s_mov_b32 s56, 32768
    s_lshl3_add_u32 s46, s33, s62
    s_mul_i32 s46, s46, 7168
    s_add_u32 s54, s54, s46
    s_add_u32 s54, s54, 9961472
    s_add_u32 s55, s45, 576
    s_branch t_3
t_2:
    s_mov_b32 s51, 1024
    s_mov_b32 s56, 256
    s_lshl2_add_u32 s54, s2, s32
    s_lshl_b32 s54, s54, 7
    s_add_u32 s54, s54, 10027008
    s_lshl1_add_u32 s42, s2, s33
    s_and_b32 s45, s42, 7
    s_bfe_u32 s62, s42, 0x30003
    s_mov_b32 s24, s68
    s_mov_b32 s25, s69
    s_mov_b32 s26, 524288
    s_lshl1_add_u32 s52, s45, s34
    s_lshl_b32 s52, s52, 15
    s_add_u32 s52, s52, 10485760
    s_add_u32 s55, s45, 608
t_3:
    s_and_b32 s25, s25, 0xffff
    s_mov_b32 s27, 0x20000
    s_lshl_b32 s46, s62, 12
    s_add_u32 s52, s52, s46
    s_lshl1_add_u32 s62, s62, s34
    s_lshl_b32 s46, s51, 5
    s_mul_i32 s50, s62, s46
    s_lshl_b32 s46, s45, 7
    s_add_u32 s50, s50, s46
    s_lshl_b32 s55, s55, 7
    v_mul_lo_u32 v62, s51, v16
    v_lshl_add_u32 v62, v18, 4, v62
    v_lshlrev_b32 v108, 10, v16
    v_lshl_add_u32 v108, v18, 4, v108
    s_lshl_b32 s51, s51, 3
    s_lshl_b32 s46, s33, 13
    s_add_u32 s46, s46, 131072
    v_bfe_u32 v16, v0, 2, 2
    v_lshrrev_b32 v18, 5, v0
    v_lshl_add_u32 v63, v18, 2, v16
    v_lshl_add_u32 v63, v63, 7, s46
    v_lshlrev_b32 v16, 5, v16
    v_and_b32 v16, 64, v16
    s_lshl_b32 s42, s34, 6
    v_xor_b32 v16, s42, v16
    v_add_u32 v63, v63, v16
    v_and_b32 v16, 16, v0
    v_lshl_add_u32 v63, v16, 1, v63
    v_and_b32 v16, 3, v0
    v_lshl_add_u32 v63, v16, 3, v63
    v_bfe_u32 v16, v0, 4, 1
    v_mul_lo_u32 v104, s56, v16
    v_lshl_add_u32 v104, v18, 9, v104
    v_and_b32 v16, 15, v0
    v_lshl_add_u32 v104, v16, 4, v104
    s_lshl_b32 s56, s34, 12
    s_add_u32 s56, s56, s46
    s_add_u32 m0, s56, 0
    s_nop 0
    buffer_load_dwordx4 v62, s[24:27], s50 offen nt lds
    s_add_u32 m0, s56, 1024
    s_add_u32 s50, s50, s51
    buffer_load_dwordx4 v62, s[24:27], s50 offen nt lds
    s_add_u32 m0, s56, 2048
    s_add_u32 s50, s50, s51
    buffer_load_dwordx4 v62, s[24:27], s50 offen nt lds
    s_add_u32 m0, s56, 3072
    s_add_u32 s50, s50, s51
    buffer_load_dwordx4 v62, s[24:27], s50 offen nt lds
    s_lshl2_add_u32 s42, s41, s32
    s_and_b32 s43, s2, 7
    s_lshl_b32 s45, s42, 14
    s_lshl_b32 s44, s43, 7
    s_add_u32 s45, s45, s44
    v_add_u32 v108, s45, v108
    s_lshl1_add_u32 s44, s43, s34
    s_mul_i32 s88, s44, 112
    s_xor_b32 s44, s44, 1
    s_mul_i32 s89, s44, 112
    s_mul_i32 s44, s41, 37
    s_lshr_b32 s44, s44, 8
    s_lshl2_add_u32 s44, s43, s44
    s_add_u32 s44, s44, 616
    s_cmp_lt_u32 s2, 224
    s_cselect_b32 s90, s44, 512
    s_cselect_b32 s44, 0, 0x4000
    s_add_u32 s42, s42, s44
    s_add_u32 s42, s42, 11264
    s_add_u32 s88, s88, s42
    s_add_u32 s89, s89, s42
    s_lshl_b32 s88, s88, 10
    s_lshl_b32 s89, s89, 10
    s_lshl_b32 s90, s90, 7
    s_lshl_b32 s43, s33, 13
    s_sub_u32 s42, s60, s43
    s_add_u32 s42, s42, 16384
    v_add_u32 v254, s42, v63
    v_xor_b32 v255, 64, v254
    s_lshl4_add_u32 s42, s35, s36
    s_lshl2_add_u32 s42, s42, s32
    s_lshl_b32 s42, s42, 10
    s_add_u32 s53, s42, 5242880
    s_lshl1_add_u32 s42, s38, s33
    s_lshl1_add_u32 s3, s42, s34
    s_lshl_b32 s42, s37, 16
    s_lshl_b32 s43, s3, 5
    s_add_u32 s86, s42, s43
    s_mul_i32 s87, s40, 448
    s_add_u32 s87, s87, 9961472
    s_mul_i32 s42, s40, 229376
    s_add_u32 s42, s42, 13631488
    s_add_u32 s91, s42, s61
    s_mul_i32 s42, s40, 7
    s_lshr_b32 s42, s42, 2
    s_add_u32 s42, s42, 575
    v_add_u32 v110, s42, v0
    v_min_u32 v110, 603, v110
    s_add_u32 s42, s38, 608
    v_writelane_b32 v110, s42, 0
    s_lshl2_add_u32 s42, s38, s32
    s_add_u32 s42, s42, 616
    v_writelane_b32 v110, s42, 4
    v_lshlrev_b32 v110, 7, v110
    s_lshl2_add_u32 s42, s39, s32
    s_lshl_b32 s42, s42, 7
    s_add_u32 s42, s42, 40964
    v_writelane_b32 v110, s42, 5
    v_mov_b32 v111, 32
    v_writelane_b32 v111, 16, 0
    v_writelane_b32 v111, 28, 4
    v_writelane_b32 v111, 8, 5
    s_add_u32 m0, s60, 147456
    s_movk_i32 s57, 7168
    buffer_load_dwordx4 v108, s[20:23], 0 offen nt lds
    buffer_load_dwordx4 v108, s[20:23], s57 offen offset:1024 nt lds
    v_bfe_u32 v16, v0, 2, 2
    v_lshlrev_b32 v8, 7, v16
    v_lshrrev_b32 v17, 5, v0
    v_lshl_add_u32 v8, v17, 12, v8
    v_lshlrev_b32 v16, 5, v16
    v_and_b32 v16, 64, v16
    s_lshl_b32 s42, s34, 6
    v_xor_b32 v16, s42, v16
    v_add_u32 v8, v8, v16
    v_and_b32 v16, 16, v0
    v_lshl_add_u32 v8, v16, 1, v8
    v_and_b32 v16, 3, v0
    v_lshl_add_u32 v8, v16, 3, v8
    s_lshl_b32 s42, s33, 11
    s_add_u32 s42, s42, 65536
    v_add_u32 v8, s42, v8
    v_xor_b32 v9, 2048, v8
    v_bfe_u32 v16, v0, 1, 3
    v_xor_b32 v18, v16, v17
    v_lshlrev_b32 v18, 4, v18
    v_and_b32 v19, 31, v0
    v_lshl_add_u32 v10, v19, 7, v18
    s_mul_i32 s42, s33, 4160
    v_xor_b32 v10, s42, v10
    v_xor_b32 v11, 32, v10
    v_xor_b32 v12, 64, v10
    v_xor_b32 v13, 96, v10
    v_lshrrev_b32 v18, 4, v0
    v_xor_b32 v16, v16, v18
    v_lshlrev_b32 v16, 4, v16
    v_and_b32 v14, 15, v0
    v_lshl_add_u32 v14, v14, 7, v16
    v_add_u32 v14, s60, v14
    v_xor_b32 v15, 64, v14
    v_lshrrev_b32 v16, 2, v0
    v_xor_b32 v16, v16, v18
    v_and_b32 v16, 1, v16
    v_cmp_eq_u32 vcc, 0, v16
    v_mov_b32 v24, 1065369472
    v_mov_b32 v25, 1065369472
    v_mov_b32 v26, 1065369472
    v_mov_b32 v27, 1065369472
    v_cndmask_b32 v20, v2, v24, vcc
    v_cndmask_b32 v21, v2, v24, vcc
    v_cndmask_b32 v22, v2, v24, vcc
    v_cndmask_b32 v23, v2, v24, vcc
    v_mov_b32 v44, 0
    v_mov_b32 v45, 0
    v_mov_b32 v46, 0
    v_mov_b32 v47, 0
    v_mov_b32 v48, 0
    v_mov_b32 v49, 0
    v_mov_b32 v50, 0
    v_mov_b32 v51, 0
    v_mov_b32 v52, 0
    v_mov_b32 v53, 0
    v_mov_b32 v54, 0
    v_mov_b32 v55, 0
    s_lshl_b32 s42, s32, 8
    s_add_u32 s42, s42, 160256
    v_lshl_add_u32 v60, v19, 2, s42
    v_xor_b32 v61, 256, v60
    v_and_b32 v105, 15, v0
    s_lshl_b32 s42, s32, 6
    s_add_u32 s42, s42, 159744
    v_lshl_add_u32 v105, v105, 2, s42
    s_lshl_b32 s42, s33, 7
    s_add_u32 s42, s42, 159744
    v_lshl_add_u32 v106, v19, 2, s42
    v_lshl_add_u32 v107, v17, 4, s42
    v_and_b32 v59, 16, v0
    v_lshlrev_b32 v59, 12, v59
    v_lshl_add_u32 v59, v17, 8, v59
    v_and_b32 v16, 15, v0
    v_lshl_add_u32 v59, v16, 4, v59
    s_lshl1_add_u32 s42, s36, s34
    s_lshl_b32 s42, s42, 7
    s_lshl1_add_u32 s43, s35, s33
    s_add_u32 s42, s42, s43
    s_lshl_b32 s42, s42, 10
    s_add_u32 s64, s42, 1048576
    s_add_u32 s65, s42, 1114112
    s_add_u32 s66, s42, 3145728
    s_lshl3_add_u32 s59, s35, s36
    s_lshl1_add_u32 s59, s59, s34
    s_lshl_b32 s59, s59, 7
    s_min_u32 s67, s35, 4
    s_lshl1_add_u32 s67, s67, 2
    v_lshlrev_b32 v112, 11, v0
    v_mov_b32 v113, 1
    s_lshl_b32 s42, s34, 12
    s_lshl_b32 s43, s33, 10
    s_add_u32 s42, s42, s43
    s_add_u32 s42, s42, 131072
    v_add_u32 v141, s42, v1
    s_add_u32 s42, s60, 131072
    v_add_u32 v142, s42, v1
    s_lshl2_add_u32 s42, s36, s32
    s_lshl_b32 s42, s42, 16
    s_add_u32 s78, s42, 1048576
    s_add_u32 s79, s42, 3145728
    v_lshrrev_b32 v16, 5, v0
    v_and_b32 v18, 15, v0
    v_lshlrev_b32 v18, 4, v18
    v_lshl_add_u32 v18, v16, 8, v18
    s_lshl_b32 s42, s35, 11
    s_sub_u32 s43, s42, 8192
    s_cselect_b32 s44, 0x40000000, s43
    s_cselect_b32 s43, 0, s43
    s_cselect_b32 s45, 0x200, -1
    s_cselect_b32 s28, 0, 0x400
    v_add_u32 v248, s44, v18
    v_and_b32 v136, s45, v1
    s_add_u32 s28, s28, s78
    v_add_u32 v136, s43, v136
    s_sub_u32 s43, s42, 6144
    s_cselect_b32 s44, 0x40000000, s43
    s_cselect_b32 s43, 0, s43
    s_cselect_b32 s45, 0x200, -1
    s_cselect_b32 s29, 0, 0x400
    v_add_u32 v249, s44, v18
    v_and_b32 v137, s45, v1
    s_add_u32 s29, s29, s78
    v_add_u32 v137, s43, v137
    s_sub_u32 s43, s42, 4096
    s_cselect_b32 s44, 0x40000000, s43
    s_cselect_b32 s43, 0, s43
    s_cselect_b32 s45, 0x200, -1
    s_cselect_b32 s30, 0, 0x400
    v_add_u32 v250, s44, v18
    v_and_b32 v138, s45, v1
    s_add_u32 s30, s30, s78
    v_add_u32 v138, s43, v138
    s_sub_u32 s43, s42, 2048
    s_cselect_b32 s44, 0x40000000, s43
    s_cselect_b32 s43, 0, s43
    s_cselect_b32 s45, 0x200, -1
    s_cselect_b32 s31, 0, 0x400
    v_add_u32 v251, s44, v18
    v_and_b32 v139, s45, v1
    s_add_u32 s31, s31, s78
    v_add_u32 v139, s43, v139
    v_add_u32 v252, s42, v18
    v_add_u32 v140, s42, v1
    s_mov_b32 s100, 0xffff
    s_mov_b32 s101, 0xffff
    s_mov_b32 s68, 572662306
    s_mov_b32 s69, 572662306
    s_mov_b32 s70, 1145324612
    s_mov_b32 s71, 1145324612
    s_mov_b32 s72, 2290649224
    s_mov_b32 s73, 2290649224
    s_mov_b32 s74, 0x00f0000f
    s_mov_b32 s75, 0xf0000f00
    v_and_b32 v16, 31, v0
    v_lshrrev_b32 v17, 5, v0
    v_lshlrev_b32 v17, 2, v17
    v_sub_u32 v16, v16, v17
    v_mov_b32 v17, 4048155338
    v_cmp_le_i32 vcc, 0, v16
    v_cmp_le_i32 s[42:43], 1, v16
    s_nop 0
    v_cndmask_b32 v208, v17, v2, vcc
    v_cndmask_b32 v224, v2, v17, vcc
    v_cndmask_b32 v209, v17, v2, s[42:43]
    v_cndmask_b32 v225, v2, v17, s[42:43]
    v_cmp_le_i32 vcc, 2, v16
    v_cmp_le_i32 s[42:43], 3, v16
    s_nop 0
    v_cndmask_b32 v210, v17, v2, vcc
    v_cndmask_b32 v226, v2, v17, vcc
    v_cndmask_b32 v211, v17, v2, s[42:43]
    v_cndmask_b32 v227, v2, v17, s[42:43]
    v_cmp_le_i32 vcc, 8, v16
    v_cmp_le_i32 s[42:43], 9, v16
    s_nop 0
    v_cndmask_b32 v212, v17, v2, vcc
    v_cndmask_b32 v228, v2, v17, vcc
    v_cndmask_b32 v213, v17, v2, s[42:43]
    v_cndmask_b32 v229, v2, v17, s[42:43]
    v_cmp_le_i32 vcc, 10, v16
    v_cmp_le_i32 s[42:43], 11, v16
    s_nop 0
    v_cndmask_b32 v214, v17, v2, vcc
    v_cndmask_b32 v230, v2, v17, vcc
    v_cndmask_b32 v215, v17, v2, s[42:43]
    v_cndmask_b32 v231, v2, v17, s[42:43]
    v_cmp_le_i32 vcc, 16, v16
    v_cmp_le_i32 s[42:43], 17, v16
    s_nop 0
    v_cndmask_b32 v216, v17, v2, vcc
    v_cndmask_b32 v232, v2, v17, vcc
    v_cndmask_b32 v217, v17, v2, s[42:43]
    v_cndmask_b32 v233, v2, v17, s[42:43]
    v_cmp_le_i32 vcc, 18, v16
    v_cmp_le_i32 s[42:43], 19, v16
    s_nop 0
    v_cndmask_b32 v218, v17, v2, vcc
    v_cndmask_b32 v234, v2, v17, vcc
    v_cndmask_b32 v219, v17, v2, s[42:43]
    v_cndmask_b32 v235, v2, v17, s[42:43]
    v_cmp_le_i32 vcc, 24, v16
    v_cmp_le_i32 s[42:43], 25, v16
    s_nop 0
    v_cndmask_b32 v220, v17, v2, vcc
    v_cndmask_b32 v236, v2, v17, vcc
    v_cndmask_b32 v221, v17, v2, s[42:43]
    v_cndmask_b32 v237, v2, v17, s[42:43]
    v_cmp_le_i32 vcc, 26, v16
    v_cmp_le_i32 s[42:43], 27, v16
    s_nop 0
    v_cndmask_b32 v222, v17, v2, vcc
    v_cndmask_b32 v238, v2, v17, vcc
    v_cndmask_b32 v223, v17, v2, s[42:43]
    v_cndmask_b32 v239, v2, v17, s[42:43]
    v_mov_b32 v17, 0xbf80bf80
    v_cndmask_b32 v240, v17, v2, s[48:49]
    v_cndmask_b32 v241, v17, v2, s[48:49]
    v_mov_b32 v242, 0
    v_mov_b32 v243, 0
    v_mov_b32 v244, 0
    v_mov_b32 v245, 0
    v_mov_b32 v246, 0
    v_mov_b32 v247, 0
    s_add_u32 s84, s84, 128
    s_add_u32 m0, s60, 16384
    s_and_b32 s84, s84, 0x380
    buffer_load_dwordx4 v4, s[8:11], s84 offen  lds
    buffer_load_dwordx4 v5, s[8:11], s84 offen offset:1024  lds
    s_add_u32 m0, s61, 81920
    s_nop 0
    buffer_load_dwordx4 v6, s[12:15], s94 offen  lds
    buffer_load_dwordx4 v7, s[12:15], s94 offen offset:2048  lds
    s_waitcnt vmcnt(14)
    s_barrier
    ds_read_b64_tr_b16 v[64:65], v8 offset:0
    ds_read_b64_tr_b16 v[66:67], v8 offset:512
    ds_read_b128 a[128:131], v10 offset:0
    ds_read_b64_tr_b16 v[68:69], v8 offset:8192
    ds_read_b64_tr_b16 v[70:71], v8 offset:8704
    ds_read_b128 a[132:135], v11 offset:0
    ds_read_b128 v[96:99], v14 offset:0
    ds_read_b64_tr_b16 v[72:73], v9 offset:0
    ds_read_b64_tr_b16 v[74:75], v9 offset:512
    ds_read_b128 a[136:139], v12 offset:0
    ds_read_b64_tr_b16 v[76:77], v9 offset:8192
    ds_read_b64_tr_b16 v[78:79], v9 offset:8704
    ds_read_b128 a[140:143], v13 offset:0
    ds_read_b128 v[100:103], v15 offset:0
    s_waitcnt lgkmcnt(7)
    v_mfma_f32_32x32x16_bf16 v[144:159], v[64:67], a[128:131], 0
    s_waitcnt vmcnt(10)
    s_barrier
    ds_read_b64_tr_b16 v[80:81], v8 offset:1024
    ds_read_b64_tr_b16 v[82:83], v8 offset:1536
    ds_read_b128 a[144:147], v10 offset:8192
    ds_read_b64_tr_b16 v[84:85], v8 offset:9216
    s_add_u32 s84, s84, 128
    s_add_u32 m0, s60, 24576
    s_and_b32 s84, s84, 0x380
    buffer_load_dwordx4 v4, s[8:11], s84 offen  lds
    buffer_load_dwordx4 v5, s[8:11], s84 offen offset:1024  lds
    v_mfma_f32_16x16x32_bf16 v[28:31], v[20:23], v[64:67], 0
    s_cmp_ge_u32 s35, 4
    s_cselect_b32 s42, 1065369472, 0
    v_accvgpr_write_b32 a40, s42
    v_accvgpr_write_b32 a41, s42
    v_mfma_f32_16x16x32_bf16 v[36:39], v[96:99], v[96:99], 0
    v_mfma_f32_32x32x16_bf16 v[144:159], v[68:71], a[132:135], v[144:159]
    ds_read_b64_tr_b16 v[86:87], v8 offset:9728
    ds_read_b128 a[148:151], v11 offset:8192
    ds_read_b128 v[116:119], v14 offset:8192
    s_add_u32 m0, s61, 82944
    s_nop 0
    buffer_load_dwordx4 v6, s[12:15], s95 offen  lds
    v_mfma_f32_16x16x32_bf16 v[28:31], v[20:23], v[68:71], v[28:31]
    v_accvgpr_write_b32 a42, s42
    v_accvgpr_write_b32 a43, s42
    v_accvgpr_write_b32 a44, s42
    v_mfma_f32_16x16x32_bf16 v[40:43], v[24:27], v[96:99], 0
    s_waitcnt lgkmcnt(7)
    v_mfma_f32_32x32x16_bf16 v[144:159], v[72:75], a[136:139], v[144:159]
    ds_read_b64_tr_b16 v[88:89], v9 offset:1024
    ds_read_b64_tr_b16 v[90:91], v9 offset:1536
    ds_read_b128 a[152:155], v12 offset:8192
    ds_read_b64_tr_b16 v[92:93], v9 offset:9216
    buffer_load_dwordx4 v7, s[12:15], s95 offen offset:2048  lds
    v_accvgpr_write_b32 a45, s42
    v_accvgpr_write_b32 a46, s42
    v_accvgpr_write_b32 a47, s42
    v_mfma_f32_16x16x32_bf16 v[36:39], v[100:103], v[100:103], v[36:39]
    v_mfma_f32_32x32x16_bf16 v[144:159], v[76:79], a[140:143], v[144:159]
    ds_read_b64_tr_b16 v[94:95], v9 offset:9728
    ds_read_b128 a[156:159], v13 offset:8192
    ds_read_b128 v[120:123], v15 offset:8192
    s_add_u32 s84, s84, 128
    s_add_u32 m0, s60, 32768
    s_and_b32 s84, s84, 0x380
    buffer_load_dwordx4 v4, s[8:11], s84 offen  lds
    v_accvgpr_write_b32 a48, s42
    v_accvgpr_write_b32 a49, s42
    v_accvgpr_write_b32 a50, s42
    v_mfma_f32_16x16x32_bf16 v[40:43], v[24:27], v[100:103], v[40:43]
    s_waitcnt lgkmcnt(7)
    v_mfma_f32_32x32x16_bf16 v[144:159], v[80:83], a[144:147], v[144:159]
    s_waitcnt vmcnt(5)
    s_barrier
    ds_read_b64_tr_b16 v[64:65], v8 offset:16384
    ds_read_b64_tr_b16 v[66:67], v8 offset:16896
    ds_read_b128 a[160:163], v10 offset:16384
    ds_read_b64_tr_b16 v[68:69], v8 offset:24576
    buffer_load_dwordx4 v5, s[8:11], s84 offen offset:1024  lds
    s_add_u32 m0, s61, 98304
    s_nop 0
    buffer_load_dwordx4 v6, s[12:15], s96 offen  lds
    v_mfma_f32_16x16x32_bf16 v[28:31], v[20:23], v[80:83], v[28:31]
    v_accvgpr_write_b32 a51, s42
    v_accvgpr_write_b32 a52, s42
    v_accvgpr_write_b32 a53, s42
    v_mfma_f32_16x16x32_bf16 v[36:39], v[116:119], v[116:119], v[36:39]
    v_mfma_f32_32x32x16_bf16 v[144:159], v[84:87], a[148:151], v[144:159]
    ds_read_b64_tr_b16 v[70:71], v8 offset:25088
    ds_read_b128 a[164:167], v11 offset:16384
    ds_read_b128 v[96:99], v14 offset:16384
    buffer_load_dwordx4 v7, s[12:15], s96 offen offset:2048  lds
    v_mfma_f32_16x16x32_bf16 v[28:31], v[20:23], v[84:87], v[28:31]
    v_accvgpr_write_b32 a54, s42
    v_accvgpr_write_b32 a55, s42
    s_cmp_ge_u32 s35, 3
    s_cselect_b32 s42, 1065369472, 0
    v_mfma_f32_16x16x32_bf16 v[40:43], v[24:27], v[116:119], v[40:43]
    s_waitcnt lgkmcnt(7)
    v_mfma_f32_32x32x16_bf16 v[144:159], v[88:91], a[152:155], v[144:159]
    ds_read_b64_tr_b16 v[72:73], v9 offset:16384
    ds_read_b64_tr_b16 v[74:75], v9 offset:16896
    ds_read_b128 a[168:171], v12 offset:16384
    ds_read_b64_tr_b16 v[76:77], v9 offset:24576
    s_add_u32 s84, s84, 128
    s_add_u32 m0, s60, 40960
    s_and_b32 s84, s84, 0x380
    buffer_load_dwordx4 v4, s[8:11], s84 offen  lds
    v_accvgpr_write_b32 a56, s42
    v_accvgpr_write_b32 a57, s42
    v_accvgpr_write_b32 a58, s42
    v_mfma_f32_16x16x32_bf16 v[36:39], v[120:123], v[120:123], v[36:39]
    v_mfma_f32_32x32x16_bf16 v[144:159], v[92:95], a[156:159], v[144:159]
    ds_read_b64_tr_b16 v[78:79], v9 offset:25088
    ds_read_b128 a[172:175], v13 offset:16384
    ds_read_b128 v[100:103], v15 offset:16384
    buffer_load_dwordx4 v5, s[8:11], s84 offen offset:1024  lds
    v_accvgpr_write_b32 a59, s42
    v_accvgpr_write_b32 a60, s42
    v_accvgpr_write_b32 a61, s42
    v_mfma_f32_16x16x32_bf16 v[40:43], v[24:27], v[120:123], v[40:43]
    s_waitcnt lgkmcnt(7)
    v_mfma_f32_32x32x16_bf16 v[144:159], v[64:67], a[160:163], v[144:159]
    s_waitcnt vmcnt(6)
    s_barrier
    ds_read_b64_tr_b16 v[80:81], v8 offset:17408
    ds_read_b64_tr_b16 v[82:83], v8 offset:17920
    ds_read_b128 a[176:179], v10 offset:24576
    ds_read_b64_tr_b16 v[84:85], v8 offset:25600
    s_add_u32 m0, s61, 99328
    s_nop 0
    buffer_load_dwordx4 v6, s[12:15], s97 offen  lds
    buffer_load_dwordx4 v7, s[12:15], s97 offen offset:2048  lds
    v_mfma_f32_16x16x32_bf16 v[28:31], v[20:23], v[64:67], v[28:31]
    v_accvgpr_write_b32 a62, s42
    v_accvgpr_write_b32 a63, s42
    v_accvgpr_write_b32 a64, s42
    v_mfma_f32_16x16x32_bf16 v[36:39], v[96:99], v[96:99], v[36:39]
    v_mfma_f32_32x32x16_bf16 v[144:159], v[68:71], a[164:167], v[144:159]
    ds_read_b64_tr_b16 v[86:87], v8 offset:26112
    ds_read_b128 a[180:183], v11 offset:24576
    ds_read_b128 v[116:119], v14 offset:24576
    s_add_u32 s84, s84, 128
    s_add_u32 m0, s60, 49152
    s_and_b32 s84, s84, 0x380
    buffer_load_dwordx4 v4, s[8:11], s84 offen  lds
    v_mfma_f32_16x16x32_bf16 v[28:31], v[20:23], v[68:71], v[28:31]
    v_accvgpr_write_b32 a65, s42
    v_accvgpr_write_b32 a66, s42
    v_accvgpr_write_b32 a67, s42
    v_mfma_f32_16x16x32_bf16 v[40:43], v[24:27], v[96:99], v[40:43]
    s_waitcnt lgkmcnt(7)
    v_mfma_f32_32x32x16_bf16 v[144:159], v[72:75], a[168:171], v[144:159]
    ds_read_b64_tr_b16 v[88:89], v9 offset:17408
    ds_read_b64_tr_b16 v[90:91], v9 offset:17920
    ds_read_b128 a[184:187], v12 offset:24576
    ds_read_b64_tr_b16 v[92:93], v9 offset:25600
    buffer_load_dwordx4 v5, s[8:11], s84 offen offset:1024  lds
    v_accvgpr_write_b32 a68, s42
    v_accvgpr_write_b32 a69, s42
    v_accvgpr_write_b32 a70, s42
    v_mfma_f32_16x16x32_bf16 v[36:39], v[100:103], v[100:103], v[36:39]
    v_mfma_f32_32x32x16_bf16 v[144:159], v[76:79], a[172:175], v[144:159]
    ds_read_b64_tr_b16 v[94:95], v9 offset:26112
    ds_read_b128 a[188:191], v13 offset:24576
    ds_read_b128 v[120:123], v15 offset:24576
    s_add_u32 m0, s61, 114688
    s_nop 0
    buffer_load_dwordx4 v6, s[12:15], s98 offen  lds
    v_accvgpr_write_b32 a71, s42
    s_cmp_ge_u32 s35, 2
    s_cselect_b32 s42, 1065369472, 0
    v_accvgpr_write_b32 a72, s42
    v_mfma_f32_16x16x32_bf16 v[40:43], v[24:27], v[100:103], v[40:43]
    s_waitcnt lgkmcnt(7)
    v_mfma_f32_32x32x16_bf16 v[144:159], v[80:83], a[176:179], v[144:159]
    s_waitcnt vmcnt(7)
    s_barrier
    s_cmp_eq_u32 s63, 3
    s_cbranch_scc0 ow_4
    s_atomic_add s58, s[80:81], 0
ow_4:
    ds_read_b64_tr_b16 v[64:65], v8 offset:32768
    ds_read_b64_tr_b16 v[66:67], v8 offset:33280
    ds_read_b128 a[192:195], v10 offset:32768
    ds_read_b64_tr_b16 v[68:69], v8 offset:40960
    buffer_load_dwordx4 v7, s[12:15], s98 offen offset:2048  lds
    s_add_u32 s84, s84, 128
    s_add_u32 m0, s60, 57344
    s_and_b32 s84, s84, 0x380
    buffer_load_dwordx4 v4, s[8:11], s84 offen  lds
    v_mfma_f32_16x16x32_bf16 v[28:31], v[20:23], v[80:83], v[28:31]
    v_accvgpr_write_b32 a73, s42
    v_accvgpr_write_b32 a74, s42
    v_accvgpr_write_b32 a75, s42
    v_mfma_f32_16x16x32_bf16 v[36:39], v[116:119], v[116:119], v[36:39]
    v_mfma_f32_32x32x16_bf16 v[144:159], v[84:87], a[180:183], v[144:159]
    ds_read_b64_tr_b16 v[70:71], v8 offset:41472
    ds_read_b128 a[196:199], v11 offset:32768
    ds_read_b128 v[96:99], v14 offset:32768
    buffer_load_dwordx4 v5, s[8:11], s84 offen offset:1024  lds
    v_mfma_f32_16x16x32_bf16 v[28:31], v[20:23], v[84:87], v[28:31]
    v_accvgpr_write_b32 a76, s42
    v_accvgpr_write_b32 a77, s42
    v_accvgpr_write_b32 a78, s42
    v_mfma_f32_16x16x32_bf16 v[40:43], v[24:27], v[116:119], v[40:43]
    s_waitcnt lgkmcnt(7)
    v_mfma_f32_32x32x16_bf16 v[144:159], v[88:91], a[184:187], v[144:159]
    ds_read_b64_tr_b16 v[72:73], v9 offset:32768
    ds_read_b64_tr_b16 v[74:75], v9 offset:33280
    ds_read_b128 a[200:203], v12 offset:32768
    ds_read_b64_tr_b16 v[76:77], v9 offset:40960
    s_add_u32 m0, s61, 115712
    s_nop 0
    buffer_load_dwordx4 v6, s[12:15], s99 offen  lds
    v_accvgpr_write_b32 a79, s42
    v_accvgpr_write_b32 a80, s42
    v_accvgpr_write_b32 a81, s42
    v_mfma_f32_16x16x32_bf16 v[36:39], v[120:123], v[120:123], v[36:39]
    v_mfma_f32_32x32x16_bf16 v[144:159], v[92:95], a[188:191], v[144:159]
    ds_read_b64_tr_b16 v[78:79], v9 offset:41472
    ds_read_b128 a[204:207], v13 offset:32768
    ds_read_b128 v[100:103], v15 offset:32768
    buffer_load_dwordx4 v7, s[12:15], s99 offen offset:2048  lds
    v_accvgpr_write_b32 a82, s42
    v_accvgpr_write_b32 a83, s42
    v_accvgpr_write_b32 a84, s42
    v_mfma_f32_16x16x32_bf16 v[40:43], v[24:27], v[120:123], v[40:43]
    s_waitcnt lgkmcnt(7)
    v_mfma_f32_32x32x16_bf16 v[144:159], v[64:67], a[192:195], v[144:159]
    s_waitcnt vmcnt(8)
    s_barrier
    ds_read_b64_tr_b16 v[80:81], v8 offset:33792
    ds_read_b64_tr_b16 v[82:83], v8 offset:34304
    ds_read_b128 a[208:211], v10 offset:40960
    ds_read_b64_tr_b16 v[84:85], v8 offset:41984
    s_add_u32 m0, s61, 65536
    s_add_u32 s92, s92, 1024
    buffer_load_dwordx4 v6, s[12:15], s92 offen  lds
    buffer_load_dwordx4 v7, s[12:15], s92 offen offset:2048  lds
    v_mfma_f32_16x16x32_bf16 v[28:31], v[20:23], v[64:67], v[28:31]
    v_accvgpr_write_b32 a85, s42
    v_accvgpr_write_b32 a86, s42
    v_accvgpr_write_b32 a87, s42
    v_mfma_f32_16x16x32_bf16 v[36:39], v[96:99], v[96:99], v[36:39]
    v_mfma_f32_32x32x16_bf16 v[144:159], v[68:71], a[196:199], v[144:159]
    ds_read_b64_tr_b16 v[86:87], v8 offset:42496
    ds_read_b128 a[212:215], v11 offset:40960
    ds_read_b128 v[116:119], v14 offset:40960
    s_add_u32 m0, s61, 66560
    s_add_u32 s93, s93, 1024
    buffer_load_dwordx4 v6, s[12:15], s93 offen  lds
    v_mfma_f32_16x16x32_bf16 v[28:31], v[20:23], v[68:71], v[28:31]
    s_cmp_ge_u32 s35, 1
    s_cselect_b32 s42, 1065369472, 0
    v_accvgpr_write_b32 a88, s42
    v_accvgpr_write_b32 a89, s42
    v_mfma_f32_16x16x32_bf16 v[40:43], v[24:27], v[96:99], v[40:43]
    s_waitcnt lgkmcnt(7)
    v_mfma_f32_32x32x16_bf16 v[144:159], v[72:75], a[200:203], v[144:159]
    ds_read_b64_tr_b16 v[88:89], v9 offset:33792
    ds_read_b64_tr_b16 v[90:91], v9 offset:34304
    ds_read_b128 a[216:219], v12 offset:40960
    ds_read_b64_tr_b16 v[92:93], v9 offset:41984
    buffer_load_dwordx4 v7, s[12:15], s93 offen offset:2048  lds
    v_accvgpr_write_b32 a90, s42
    v_accvgpr_write_b32 a91, s42
    v_accvgpr_write_b32 a92, s42
    v_mfma_f32_16x16x32_bf16 v[36:39], v[100:103], v[100:103], v[36:39]
    v_mfma_f32_32x32x16_bf16 v[144:159], v[76:79], a[204:207], v[144:159]
    ds_read_b64_tr_b16 v[94:95], v9 offset:42496
    ds_read_b128 a[220:223], v13 offset:40960
    ds_read_b128 v[120:123], v15 offset:40960
    s_add_u32 m0, s61, 81920
    s_add_u32 s94, s94, 1024
    buffer_load_dwordx4 v6, s[12:15], s94 offen  lds
    v_accvgpr_write_b32 a93, s42
    v_accvgpr_write_b32 a94, s42
    v_accvgpr_write_b32 a95, s42
    v_mfma_f32_16x16x32_bf16 v[40:43], v[24:27], v[100:103], v[40:43]
    s_waitcnt lgkmcnt(7)
    v_mfma_f32_32x32x16_bf16 v[144:159], v[80:83], a[208:211], v[144:159]
    s_waitcnt vmcnt(9)
    s_barrier
    ds_read_b64_tr_b16 v[64:65], v8 offset:49152
    ds_read_b64_tr_b16 v[66:67], v8 offset:49664
    ds_read_b128 a[224:227], v10 offset:49152
    ds_read_b64_tr_b16 v[68:69], v8 offset:57344
    buffer_load_dwordx4 v7, s[12:15], s94 offen offset:2048  lds
    s_add_u32 m0, s61, 82944
    s_add_u32 s95, s95, 1024
    buffer_load_dwordx4 v6, s[12:15], s95 offen  lds
    v_mfma_f32_16x16x32_bf16 v[28:31], v[20:23], v[80:83], v[28:31]
    v_accvgpr_write_b32 a96, s42
    v_accvgpr_write_b32 a97, s42
    v_accvgpr_write_b32 a98, s42
    v_mfma_f32_16x16x32_bf16 v[36:39], v[116:119], v[116:119], v[36:39]
    v_mfma_f32_32x32x16_bf16 v[144:159], v[84:87], a[212:215], v[144:159]
    ds_read_b64_tr_b16 v[70:71], v8 offset:57856
    ds_read_b128 a[228:231], v11 offset:49152
    ds_read_b128 v[96:99], v14 offset:49152
    buffer_load_dwordx4 v7, s[12:15], s95 offen offset:2048  lds
    v_mfma_f32_16x16x32_bf16 v[28:31], v[20:23], v[84:87], v[28:31]
    v_accvgpr_write_b32 a99, s42
    v_accvgpr_write_b32 a100, s42
    v_accvgpr_write_b32 a101, s42
    v_mfma_f32_16x16x32_bf16 v[40:43], v[24:27], v[116:119], v[40:43]
    s_waitcnt lgkmcnt(7)
    v_mfma_f32_32x32x16_bf16 v[144:159], v[88:91], a[216:219], v[144:159]
    ds_read_b64_tr_b16 v[72:73], v9 offset:49152
    ds_read_b64_tr_b16 v[74:75], v9 offset:49664
    ds_read_b128 a[232:235], v12 offset:49152
    ds_read_b64_tr_b16 v[76:77], v9 offset:57344
    s_add_u32 m0, s61, 98304
    s_add_u32 s96, s96, 1024
    buffer_load_dwordx4 v6, s[12:15], s96 offen  lds
    v_accvgpr_write_b32 a102, s42
    v_accvgpr_write_b32 a103, s42
    v_accvgpr_write_b32 a104, v24
    v_mfma_f32_16x16x32_bf16 v[36:39], v[120:123], v[120:123], v[36:39]
    v_mfma_f32_32x32x16_bf16 v[144:159], v[92:95], a[220:223], v[144:159]
    ds_read_b64_tr_b16 v[78:79], v9 offset:57856
    ds_read_b128 a[236:239], v13 offset:49152
    ds_read_b128 v[100:103], v15 offset:49152
    buffer_load_dwordx4 v7, s[12:15], s96 offen offset:2048  lds
    v_accvgpr_write_b32 a105, v24
    v_accvgpr_write_b32 a106, v24
    v_accvgpr_write_b32 a107, v24
    v_mfma_f32_16x16x32_bf16 v[40:43], v[24:27], v[120:123], v[40:43]
    s_waitcnt lgkmcnt(7)
    v_mfma_f32_32x32x16_bf16 v[144:159], v[64:67], a[224:227], v[144:159]
    s_waitcnt vmcnt(10)
    s_barrier
    ds_read_b64_tr_b16 v[80:81], v8 offset:50176
    ds_read_b64_tr_b16 v[82:83], v8 offset:50688
    ds_read_b128 a[240:243], v10 offset:57344
    ds_read_b64_tr_b16 v[84:85], v8 offset:58368
    s_add_u32 m0, s61, 0
    s_add_u32 s92, s92, -2048
    buffer_load_dwordx4 v6, s[12:15], s92 offen  lds
    buffer_load_dwordx4 v7, s[12:15], s92 offen offset:2048  lds
    v_mfma_f32_16x16x32_bf16 v[28:31], v[20:23], v[64:67], v[28:31]
    v_accvgpr_write_b32 a108, v24
    v_accvgpr_write_b32 a109, v24
    v_accvgpr_write_b32 a110, v24
    v_mfma_f32_16x16x32_bf16 v[36:39], v[96:99], v[96:99], v[36:39]
    v_mfma_f32_32x32x16_bf16 v[144:159], v[68:71], a[228:231], v[144:159]
    ds_read_b64_tr_b16 v[86:87], v8 offset:58880
    ds_read_b128 a[244:247], v11 offset:57344
    ds_read_b128 v[116:119], v14 offset:57344
    s_add_u32 m0, s61, 99328
    s_add_u32 s97, s97, 1024
    buffer_load_dwordx4 v6, s[12:15], s97 offen  lds
    v_mfma_f32_16x16x32_bf16 v[28:31], v[20:23], v[68:71], v[28:31]
    v_accvgpr_write_b32 a111, v24
    v_accvgpr_write_b32 a112, v24
    v_accvgpr_write_b32 a113, v24
    v_mfma_f32_16x16x32_bf16 v[40:43], v[24:27], v[96:99], v[40:43]
    s_waitcnt lgkmcnt(7)
    v_mfma_f32_32x32x16_bf16 v[144:159], v[72:75], a[232:235], v[144:159]
    ds_read_b64_tr_b16 v[88:89], v9 offset:50176
    ds_read_b64_tr_b16 v[90:91], v9 offset:50688
    ds_read_b128 a[248:251], v12 offset:57344
    ds_read_b64_tr_b16 v[92:93], v9 offset:58368
    buffer_load_dwordx4 v7, s[12:15], s97 offen offset:2048  lds
    v_accvgpr_write_b32 a114, v24
    v_accvgpr_write_b32 a115, v24
    v_accvgpr_write_b32 a116, v24
    v_mfma_f32_16x16x32_bf16 v[36:39], v[100:103], v[100:103], v[36:39]
    v_mfma_f32_32x32x16_bf16 v[144:159], v[76:79], a[236:239], v[144:159]
    ds_read_b64_tr_b16 v[94:95], v9 offset:58880
    ds_read_b128 a[252:255], v13 offset:57344
    ds_read_b128 v[120:123], v15 offset:57344
    v_accvgpr_write_b32 a117, v24
    v_accvgpr_write_b32 a118, v24
    v_accvgpr_write_b32 a119, v24
    v_mfma_f32_16x16x32_bf16 v[40:43], v[24:27], v[100:103], v[40:43]
    s_waitcnt lgkmcnt(7)
    v_mfma_f32_16x16x32_bf16 v[36:39], v[116:119], v[116:119], v[36:39]
    v_mfma_f32_16x16x32_bf16 v[40:43], v[24:27], v[116:119], v[40:43]
    s_waitcnt vmcnt(10)
    s_barrier
    v_mfma_f32_16x16x32_bf16 v[28:31], v[20:23], v[80:83], v[28:31]
    ds_read_b64_tr_b16 v[64:65], v8 offset:0
    ds_read_b64_tr_b16 v[66:67], v8 offset:512
    ds_read_b64_tr_b16 v[68:69], v8 offset:8192
    v_mfma_f32_16x16x32_bf16 v[28:31], v[20:23], v[84:87], v[28:31]
    ds_read_b64_tr_b16 v[70:71], v8 offset:8704
    s_add_u32 m0, s61, 114688
    s_add_u32 s98, s98, 1024
    buffer_load_dwordx4 v6, s[12:15], s98 offen  lds
    s_waitcnt lgkmcnt(4)
    v_mfma_f32_16x16x32_bf16 v[36:39], v[120:123], v[120:123], v[36:39]
    ds_read_b64_tr_b16 v[72:73], v9 offset:0
    ds_read_b64_tr_b16 v[74:75], v9 offset:512
    ds_read_b64_tr_b16 v[76:77], v9 offset:8192
    v_mfma_f32_16x16x32_bf16 v[40:43], v[24:27], v[120:123], v[40:43]
    ds_read_b64_tr_b16 v[78:79], v9 offset:8704
    buffer_load_dwordx4 v7, s[12:15], s98 offen offset:2048  lds
    v_mfma_f32_32x32x16_bf16 v[144:159], v[80:83], a[240:243], v[144:159]
    ds_write_b32 v60, v28
    v_cndmask_b32 v36, v36, v37, s[68:69]
    s_nop 2
    v_mul_f32 v56, 0x3b000000, v40
    v_cndmask_b32 v36, v36, v38, s[70:71]
    v_cndmask_b32 v36, v36, v39, s[72:73]
    v_mfma_f32_32x32x16_bf16 v[144:159], v[84:87], a[244:247], v[144:159]
    v_mul_f32 v57, 0x3b000000, v36
    v_fma_f32 v57, -v56, v56, v57
    v_max_f32 v57, 0, v57
    v_add_f32 v57, 0x3727c5ac, v57
    v_rsq_f32 v57, v57
    s_mov_b64 exec, s[74:75]
    ds_write2_b32 v105, v56, v57 offset0:0 offset1:64
    s_mov_b64 exec, -1
    v_mfma_f32_32x32x16_bf16 v[144:159], v[88:91], a[248:251], v[144:159]
    s_waitcnt lgkmcnt(0)
    s_barrier
    ds_read2_b32 v[56:57], v106 offset0:0 offset1:64
    ds_read_b32 v18, v61
    v_mfma_f32_32x32x16_bf16 v[144:159], v[92:95], a[252:255], v[144:159]
    ds_read_b128 v[192:195], v107 offset:256
    ds_read_b128 v[196:199], v107 offset:288
    ds_read_b128 v[200:203], v107 offset:320
    ds_read_b128 v[204:207], v107 offset:352
    s_add_u32 m0, s61, 115712
    s_add_u32 s99, s99, 1024
    buffer_load_dwordx4 v6, s[12:15], s99 offen  lds
    v_mfma_f32_32x32x16_bf16 v[160:175], a[128:131], v[64:67], 0
    ds_read_b64_tr_b16 v[80:81], v8 offset:1024
    ds_read_b64_tr_b16 v[82:83], v8 offset:1536
    buffer_load_dwordx4 v7, s[12:15], s99 offen offset:2048  lds
    v_mfma_f32_16x16x32_bf16 v[32:35], v[20:23], v[64:67], 0
    s_waitcnt lgkmcnt(6)
    v_add_f32 v28, v28, v18
    v_cvt_pk_bf16_f32 v16, -v56, -v56
    v_cvt_pk_bf16_f32 v18, v28, v28
    v_and_b32 v17, 0xffff0000, v16
    v_and_b32 v18, 0xffff0000, v18
    v_sub_f32 v17, -v56, v17
    v_sub_f32 v48, v28, v18
    v_mfma_f32_32x32x16_bf16 v[160:175], a[132:135], v[68:71], v[160:175]
    ds_read_b64_tr_b16 v[84:85], v8 offset:9216
    ds_read_b64_tr_b16 v[86:87], v8 offset:9728
    v_mfma_f32_16x16x32_bf16 v[32:35], v[20:23], v[68:71], v[32:35]
    v_cvt_pk_bf16_f32 v17, v17, v17
    v_cvt_pk_bf16_f32 v48, v18, v48
    v_cndmask_b32 v44, v16, v17, s[48:49]
    s_mov_b32 s69, 0x07060302
    s_lshr_b32 s42, s36, 1
    v_mfma_f32_32x32x16_bf16 v[144:159], v[48:51], v[44:47], v[144:159]
    s_lshl2_add_u32 s42, s35, s42
    s_lshl_b32 s71, s42, 7
    v_mfma_f32_32x32x16_bf16 v[160:175], a[136:139], v[72:75], v[160:175]
    ds_read_b64_tr_b16 v[88:89], v9 offset:1024
    ds_read_b64_tr_b16 v[90:91], v9 offset:1536
    s_lshl2_add_u32 s42, s37, s32
    s_lshl_b32 s72, s42, 7
    s_lshl1_add_u32 s42, s38, s33
    s_lshl2_add_u32 s42, s42, s32
    global_load_dword v58, v2, s[80:81] sc1
    s_nop 1
    v_mul_f32 v144, v144, v57
    v_mul_f32 v145, v145, v57
    v_mul_f32 v146, v146, v57
    v_mfma_f32_32x32x16_bf16 v[160:175], a[140:143], v[76:79], v[160:175]
    ds_read_b64_tr_b16 v[92:93], v9 offset:9216
    ds_read_b64_tr_b16 v[94:95], v9 offset:9728
    v_mul_f32 v147, v147, v57
    v_mul_f32 v148, v148, v57
    v_mul_f32 v149, v149, v57
    v_mul_f32 v150, v150, v57
    v_mul_f32 v151, v151, v57
    v_cvt_pk_bf16_f32 v144, v144, v145
    v_cvt_pk_bf16_f32 v145, v146, v147
    v_cvt_pk_bf16_f32 v146, v148, v149
    s_waitcnt lgkmcnt(4)
    v_mfma_f32_32x32x16_bf16 v[160:175], a[144:147], v[80:83], v[160:175]
    s_waitcnt vmcnt(11)
    s_barrier
    ds_read_b64_tr_b16 v[64:65], v8 offset:16384
    ds_read_b64_tr_b16 v[66:67], v8 offset:16896
    v_mfma_f32_16x16x32_bf16 v[32:35], v[20:23], v[80:83], v[32:35]
    v_cvt_pk_bf16_f32 v147, v150, v151
    buffer_store_dwordx4 v[144:147], v1, s[16:19], s64 offen sc1
    v_mul_f32 v152, v152, v57
    v_mul_f32 v153, v153, v57
    v_mul_f32 v154, v154, v57
    v_mul_f32 v155, v155, v57
    v_mul_f32 v156, v156, v57
    v_mul_f32 v157, v157, v57
    v_mfma_f32_32x32x16_bf16 v[160:175], a[148:151], v[84:87], v[160:175]
    ds_read_b64_tr_b16 v[68:69], v8 offset:24576
    ds_read_b64_tr_b16 v[70:71], v8 offset:25088
    v_mfma_f32_16x16x32_bf16 v[32:35], v[20:23], v[84:87], v[32:35]
    v_mul_f32 v158, v158, v57
    v_mul_f32 v159, v159, v57
    v_cvt_pk_bf16_f32 v148, v152, v153
    v_cvt_pk_bf16_f32 v149, v154, v155
    v_cvt_pk_bf16_f32 v150, v156, v157
    v_cvt_pk_bf16_f32 v151, v158, v159
    buffer_store_dwordx4 v[148:151], v1, s[16:19], s65 offen sc1
    s_waitcnt lgkmcnt(4)
    v_mfma_f32_32x32x16_bf16 v[160:175], a[152:155], v[88:91], v[160:175]
    ds_read_b64_tr_b16 v[72:73], v9 offset:16384
    ds_read_b64_tr_b16 v[74:75], v9 offset:16896
    s_lshl_b32 s42, s42, 13
    s_add_u32 s74, s42, 10485760
    s_xor_b32 s75, s74, 32768
    s_lshl3_add_u32 s42, s37, s32
    s_lshl_b32 s42, s42, 13
    s_add_u32 s73, s42, 5242880
    v_mfma_f32_32x32x16_bf16 v[160:175], a[156:159], v[92:95], v[160:175]
    ds_read_b64_tr_b16 v[76:77], v9 offset:24576
    ds_read_b64_tr_b16 v[78:79], v9 offset:25088
    s_add_u32 m0, s61, 1024
    s_add_u32 s93, s93, -2048
    buffer_load_dwordx4 v6, s[12:15], s93 offen  lds
    s_waitcnt lgkmcnt(4)
    v_mfma_f32_32x32x16_bf16 v[160:175], a[160:163], v[64:67], v[160:175]
    ds_read_b64_tr_b16 v[80:81], v8 offset:17408
    ds_read_b64_tr_b16 v[82:83], v8 offset:17920
    buffer_load_dwordx4 v7, s[12:15], s93 offen offset:2048  lds
    v_mfma_f32_16x16x32_bf16 v[32:35], v[20:23], v[64:67], v[32:35]
    v_mfma_f32_32x32x16_bf16 v[160:175], a[164:167], v[68:71], v[160:175]
    ds_read_b64_tr_b16 v[84:85], v8 offset:25600
    ds_read_b64_tr_b16 v[86:87], v8 offset:26112
    s_add_u32 m0, s61, 16384
    s_add_u32 s94, s94, -2048
    buffer_load_dwordx4 v6, s[12:15], s94 offen  lds
    v_mfma_f32_16x16x32_bf16 v[32:35], v[20:23], v[68:71], v[32:35]
    s_waitcnt lgkmcnt(4)
    v_mfma_f32_32x32x16_bf16 v[160:175], a[168:171], v[72:75], v[160:175]
    ds_read_b64_tr_b16 v[88:89], v9 offset:17408
    ds_read_b64_tr_b16 v[90:91], v9 offset:17920
    v_mfma_f32_32x32x16_bf16 v[160:175], a[172:175], v[76:79], v[160:175]
    ds_read_b64_tr_b16 v[92:93], v9 offset:25600
    ds_read_b64_tr_b16 v[94:95], v9 offset:26112
    buffer_load_dwordx4 v7, s[12:15], s94 offen offset:2048  lds
    s_waitcnt lgkmcnt(4)
    v_mfma_f32_32x32x16_bf16 v[160:175], a[176:179], v[80:83], v[160:175]
    s_waitcnt vmcnt(7)
    s_barrier
    ds_read_b64_tr_b16 v[64:65], v8 offset:32768
    ds_read_b64_tr_b16 v[66:67], v8 offset:33280
    s_add_u32 m0, s61, 17408
    s_add_u32 s95, s95, -2048
    buffer_load_dwordx4 v6, s[12:15], s95 offen  lds
    v_mfma_f32_16x16x32_bf16 v[32:35], v[20:23], v[80:83], v[32:35]
    ds_read_b64_tr_b16 v[116:117], v63 offset:0
    ds_read_b64_tr_b16 v[118:119], v63 offset:1024
    ds_read_b64_tr_b16 v[120:121], v63 offset:2048
    ds_read_b64_tr_b16 v[122:123], v63 offset:3072
    ds_read_b64_tr_b16 v[124:125], v63 offset:4096
    ds_read_b64_tr_b16 v[126:127], v63 offset:5120
    ds_read_b64_tr_b16 v[128:129], v63 offset:6144
    ds_read_b64_tr_b16 v[130:131], v63 offset:7168
    v_mfma_f32_32x32x16_bf16 v[160:175], a[180:183], v[84:87], v[160:175]
    ds_read_b64_tr_b16 v[68:69], v8 offset:40960
    ds_read_b64_tr_b16 v[70:71], v8 offset:41472
    buffer_load_dwordx4 v7, s[12:15], s95 offen offset:2048  lds
    v_mfma_f32_16x16x32_bf16 v[32:35], v[20:23], v[84:87], v[32:35]
    s_waitcnt lgkmcnt(2)
    v_mfma_f32_16x16x32_bf16 v[132:135], v[20:23], v[116:119], 0
    v_mfma_f32_16x16x32_bf16 v[132:135], v[20:23], v[120:123], v[132:135]
    v_mfma_f32_16x16x32_bf16 v[132:135], v[20:23], v[124:127], v[132:135]
    v_mfma_f32_16x16x32_bf16 v[132:135], v[20:23], v[128:131], v[132:135]
    v_mfma_f32_32x32x16_bf16 v[160:175], a[184:187], v[88:91], v[160:175]
    ds_read_b64_tr_b16 v[72:73], v9 offset:32768
    ds_read_b64_tr_b16 v[74:75], v9 offset:33280
    v_mfma_f32_32x32x16_bf16 v[160:175], a[188:191], v[92:95], v[160:175]
    ds_read_b64_tr_b16 v[76:77], v9 offset:40960
    ds_read_b64_tr_b16 v[78:79], v9 offset:41472
    s_add_u32 m0, s61, 32768
    s_add_u32 s96, s96, -2048
    buffer_load_dwordx4 v6, s[12:15], s96 offen  lds
    s_waitcnt lgkmcnt(4)
    v_mfma_f32_32x32x16_bf16 v[160:175], a[192:195], v[64:67], v[160:175]
    ds_read_b64_tr_b16 v[80:81], v8 offset:33792
    ds_read_b64_tr_b16 v[82:83], v8 offset:34304
    buffer_load_dwordx4 v7, s[12:15], s96 offen offset:2048  lds
    v_mfma_f32_16x16x32_bf16 v[32:35], v[20:23], v[64:67], v[32:35]
    v_mfma_f32_32x32x16_bf16 v[160:175], a[196:199], v[68:71], v[160:175]
    ds_read_b64_tr_b16 v[84:85], v8 offset:41984
    ds_read_b64_tr_b16 v[86:87], v8 offset:42496
    s_add_u32 m0, s61, 33792
    s_add_u32 s97, s97, -2048
    buffer_load_dwordx4 v6, s[12:15], s97 offen  lds
    v_mfma_f32_16x16x32_bf16 v[32:35], v[20:23], v[68:71], v[32:35]
    s_waitcnt lgkmcnt(4)
    v_mfma_f32_32x32x16_bf16 v[160:175], a[200:203], v[72:75], v[160:175]
    ds_read_b64_tr_b16 v[88:89], v9 offset:33792
    ds_read_b64_tr_b16 v[90:91], v9 offset:34304
    v_mfma_f32_32x32x16_bf16 v[160:175], a[204:207], v[76:79], v[160:175]
    ds_read_b64_tr_b16 v[92:93], v9 offset:41984
    ds_read_b64_tr_b16 v[94:95], v9 offset:42496
    buffer_load_dwordx4 v7, s[12:15], s97 offen offset:2048  lds
    s_waitcnt lgkmcnt(4)
    v_mfma_f32_32x32x16_bf16 v[160:175], a[208:211], v[80:83], v[160:175]
    s_waitcnt vmcnt(10)
    v_cmp_le_u32 vcc, 41, v58
    s_cbranch_vccz ps_5
pb_6:
    s_mov_b64 exec, 31
    buffer_atomic_add v113, v112, s[16:19], s59 offen offset:0 sc1
    s_mov_b64 exec, -1
    ds_read_b64_tr_b16 v[64:65], v8 offset:49152
    ds_read_b64_tr_b16 v[66:67], v8 offset:49664
    s_add_u32 m0, s61, 49152
    s_add_u32 s98, s98, -2048
    buffer_load_dwordx4 v6, s[12:15], s98 offen  lds
    v_mfma_f32_16x16x32_bf16 v[32:35], v[20:23], v[80:83], v[32:35]
    v_mfma_f32_32x32x16_bf16 v[160:175], a[212:215], v[84:87], v[160:175]
    ds_read_b64_tr_b16 v[68:69], v8 offset:57344
    ds_read_b64_tr_b16 v[70:71], v8 offset:57856
    buffer_load_dwordx4 v7, s[12:15], s98 offen offset:2048  lds
    v_mfma_f32_16x16x32_bf16 v[32:35], v[20:23], v[84:87], v[32:35]
    s_waitcnt lgkmcnt(4)
    v_mfma_f32_32x32x16_bf16 v[160:175], a[216:219], v[88:91], v[160:175]
    ds_read_b64_tr_b16 v[72:73], v9 offset:49152
    ds_read_b64_tr_b16 v[74:75], v9 offset:49664
    v_mfma_f32_32x32x16_bf16 v[160:175], a[220:223], v[92:95], v[160:175]
    ds_read_b64_tr_b16 v[76:77], v9 offset:57344
    ds_read_b64_tr_b16 v[78:79], v9 offset:57856
    s_add_u32 m0, s61, 50176
    s_add_u32 s99, s99, -2048
    buffer_load_dwordx4 v6, s[12:15], s99 offen  lds
    s_waitcnt lgkmcnt(4)
    v_mfma_f32_32x32x16_bf16 v[160:175], a[224:227], v[64:67], v[160:175]
    ds_read_b64_tr_b16 v[80:81], v8 offset:50176
    ds_read_b64_tr_b16 v[82:83], v8 offset:50688
    buffer_load_dwordx4 v7, s[12:15], s99 offen offset:2048  lds
    v_mfma_f32_16x16x32_bf16 v[32:35], v[20:23], v[64:67], v[32:35]
    v_mfma_f32_32x32x16_bf16 v[160:175], a[228:231], v[68:71], v[160:175]
    ds_read_b64_tr_b16 v[84:85], v8 offset:58368
    ds_read_b64_tr_b16 v[86:87], v8 offset:58880
    buffer_store_dwordx4 v[116:119], v104, s[16:19], s52 offen offset:0 sc1
    v_mfma_f32_16x16x32_bf16 v[32:35], v[20:23], v[68:71], v[32:35]
    s_waitcnt lgkmcnt(4)
    v_mfma_f32_32x32x16_bf16 v[160:175], a[232:235], v[72:75], v[160:175]
    ds_read_b64_tr_b16 v[88:89], v9 offset:50176
    ds_read_b64_tr_b16 v[90:91], v9 offset:50688
    v_mfma_f32_32x32x16_bf16 v[160:175], a[236:239], v[76:79], v[160:175]
    ds_read_b64_tr_b16 v[92:93], v9 offset:58368
    ds_read_b64_tr_b16 v[94:95], v9 offset:58880
    buffer_store_dwordx4 v[120:123], v104, s[16:19], s52 offen offset:1024 sc1
    s_waitcnt lgkmcnt(4)
    v_mfma_f32_16x16x32_bf16 v[32:35], v[20:23], v[80:83], v[32:35]
    v_mfma_f32_16x16x32_bf16 v[32:35], v[20:23], v[84:87], v[32:35]
    v_add_u32 v8, 4294901760, v8
    v_add_u32 v9, 4294901760, v9
    v_mfma_f32_32x32x16_bf16 v[160:175], a[240:243], v[80:83], v[160:175]
    s_waitcnt vmcnt(11)
    s_barrier
    ds_read_b64_tr_b16 v[64:65], v8 offset:0
    ds_read_b64_tr_b16 v[66:67], v8 offset:512
    ds_read_b64_tr_b16 v[68:69], v8 offset:8192
    ds_read_b64_tr_b16 v[70:71], v8 offset:8704
    buffer_store_dwordx4 v[124:127], v104, s[16:19], s52 offen offset:2048 sc1
    ds_write_b32 v60, v32 offset:128
    v_mfma_f32_32x32x16_bf16 v[160:175], a[244:247], v[84:87], v[160:175]
    ds_read_b64_tr_b16 v[72:73], v9 offset:0
    ds_read_b64_tr_b16 v[74:75], v9 offset:512
    buffer_store_dwordx4 v[128:131], v104, s[16:19], s52 offen offset:3072 sc1
    s_waitcnt lgkmcnt(2)
    v_mfma_f32_32x32x16_bf16 v[160:175], a[248:251], v[88:91], v[160:175]
    s_barrier
    ds_read_b32 v18, v61 offset:128
    ds_read_b64_tr_b16 v[76:77], v9 offset:8192
    ds_read_b64_tr_b16 v[78:79], v9 offset:8704
    v_lshlrev_b32 v62, 2, v0
    s_mov_b32 exec_hi, 0
    buffer_store_dword v132, v62, s[16:19], s54 offen sc1
    s_mov_b32 exec_hi, -1
    v_mfma_f32_32x32x16_bf16 v[160:175], a[252:255], v[92:95], v[160:175]
    s_waitcnt lgkmcnt(2)
    v_add_f32 v32, v32, v18
    v_cvt_pk_bf16_f32 v18, v32, v32
    v_and_b32 v18, 0xffff0000, v18
    v_sub_f32 v52, v32, v18
    v_cvt_pk_bf16_f32 v52, v18, v52
    v_mul_f32 v57, 0x3eb8aa3b, v57
    v_mov_b32 v56, v57
    v_mfma_f32_32x32x16_bf16 v[160:175], v[44:47], v[52:55], v[160:175]
    v_mfma_f32_32x32x16_bf16 v[176:191], v[64:67], a[128:131], 0
    s_mov_b32 s62, 0
    s_atomic_umax s62, s[82:83], s59 offset:0 glc
    ds_read_b64_tr_b16 v[80:81], v8 offset:1024
    ds_read_b64_tr_b16 v[82:83], v8 offset:1536
    v_mfma_f32_16x16x32_bf16 v[28:31], v[20:23], v[64:67], 0
    s_nop 5
    v_mul_f32 v160, v160, v192
    v_mul_f32 v161, v161, v193
    v_mul_f32 v162, v162, v194
    v_mul_f32 v163, v163, v195
    v_mul_f32 v164, v164, v196
    v_mul_f32 v165, v165, v197
    v_mfma_f32_32x32x16_bf16 v[176:191], v[68:71], a[132:135], v[176:191]
    ds_read_b64_tr_b16 v[84:85], v8 offset:9216
    ds_read_b64_tr_b16 v[86:87], v8 offset:9728
    v_mfma_f32_16x16x32_bf16 v[28:31], v[20:23], v[68:71], v[28:31]
    v_mul_f32 v166, v166, v198
    v_mul_f32 v167, v167, v199
    v_cvt_pk_bf16_f32 v160, v160, v161
    v_cvt_pk_bf16_f32 v161, v162, v163
    v_cvt_pk_bf16_f32 v162, v164, v165
    v_cvt_pk_bf16_f32 v163, v166, v167
    buffer_store_dwordx4 v[160:163], v59, s[16:19], s66 offen offset:0 sc1
    v_mul_f32 v168, v168, v200
    s_waitcnt lgkmcnt(4)
    v_mfma_f32_32x32x16_bf16 v[176:191], v[72:75], a[136:139], v[176:191]
    ds_read_b64_tr_b16 v[88:89], v9 offset:1024
    ds_read_b64_tr_b16 v[90:91], v9 offset:1536
    v_mul_f32 v169, v169, v201
    v_mul_f32 v170, v170, v202
    v_mul_f32 v171, v171, v203
    v_mul_f32 v172, v172, v204
    v_mul_f32 v173, v173, v205
    v_mul_f32 v174, v174, v206
    v_mul_f32 v175, v175, v207
    v_cvt_pk_bf16_f32 v164, v168, v169
    v_mfma_f32_32x32x16_bf16 v[176:191], v[76:79], a[140:143], v[176:191]
    ds_read_b64_tr_b16 v[92:93], v9 offset:9216
    ds_read_b64_tr_b16 v[94:95], v9 offset:9728
    v_cvt_pk_bf16_f32 v165, v170, v171
    v_cvt_pk_bf16_f32 v166, v172, v173
    v_cvt_pk_bf16_f32 v167, v174, v175
    buffer_store_dwordx4 v[164:167], v59, s[16:19], s66 offen offset:512 sc1
    s_waitcnt lgkmcnt(4)
    v_mfma_f32_32x32x16_bf16 v[176:191], v[80:83], a[144:147], v[176:191]
    ds_read_b64_tr_b16 v[64:65], v8 offset:16384
    ds_read_b64_tr_b16 v[66:67], v8 offset:16896
    v_lshrrev_b32 v16, 3, v0
    v_xor_b32 v17, v16, v0
    v_and_b32 v17, 7, v17
    v_lshlrev_b32 v17, 4, v17
    v_lshl_add_u32 v16, v16, 10, v17
    s_lshl2_add_u32 s84, s37, s32
    s_lshl_b32 s84, s84, 7
    s_add_u32 s84, s84, s38
    s_lshl_b32 s84, s84, 7
    s_add_u32 m0, s60, 139264
    s_add_u32 s57, s84, 7168
    buffer_load_dwordx4 v16, s[8:11], s84 offen lds
    buffer_load_dwordx4 v16, s[8:11], s57 offen offset:1024 lds
    v_mfma_f32_16x16x32_bf16 v[28:31], v[20:23], v[80:83], v[28:31]
    v_mfma_f32_32x32x16_bf16 v[176:191], v[84:87], a[148:151], v[176:191]
    ds_read_b64_tr_b16 v[68:69], v8 offset:24576
    ds_read_b64_tr_b16 v[70:71], v8 offset:25088
    v_mfma_f32_16x16x32_bf16 v[28:31], v[20:23], v[84:87], v[28:31]
    s_waitcnt lgkmcnt(4)
    v_mfma_f32_32x32x16_bf16 v[176:191], v[88:91], a[152:155], v[176:191]
    ds_read_b64_tr_b16 v[72:73], v9 offset:16384
    ds_read_b64_tr_b16 v[74:75], v9 offset:16896
    v_mfma_f32_32x32x16_bf16 v[176:191], v[92:95], a[156:159], v[176:191]
    ds_read_b64_tr_b16 v[76:77], v9 offset:24576
    ds_read_b64_tr_b16 v[78:79], v9 offset:25088
    s_waitcnt lgkmcnt(4)
    v_mfma_f32_32x32x16_bf16 v[176:191], v[64:67], a[160:163], v[176:191]
    ds_read_b64_tr_b16 v[80:81], v8 offset:17408
    ds_read_b64_tr_b16 v[82:83], v8 offset:17920
    v_mfma_f32_16x16x32_bf16 v[28:31], v[20:23], v[64:67], v[28:31]
    v_mfma_f32_32x32x16_bf16 v[176:191], v[68:71], a[164:167], v[176:191]
    ds_read_b64_tr_b16 v[84:85], v8 offset:25600
    ds_read_b64_tr_b16 v[86:87], v8 offset:26112
    v_mfma_f32_16x16x32_bf16 v[28:31], v[20:23], v[68:71], v[28:31]
    s_waitcnt lgkmcnt(4)
    v_mfma_f32_32x32x16_bf16 v[176:191], v[72:75], a[168:171], v[176:191]
    ds_read_b64_tr_b16 v[88:89], v9 offset:17408
    ds_read_b64_tr_b16 v[90:91], v9 offset:17920
    v_mfma_f32_32x32x16_bf16 v[176:191], v[76:79], a[172:175], v[176:191]
    ds_read_b64_tr_b16 v[92:93], v9 offset:25600
    ds_read_b64_tr_b16 v[94:95], v9 offset:26112
    s_waitcnt lgkmcnt(4)
    v_mfma_f32_32x32x16_bf16 v[176:191], v[80:83], a[176:179], v[176:191]
    s_waitcnt vmcnt(9)
    s_barrier
    s_cmp_ge_u32 s62, s67
    s_cbranch_scc0 ps_8
pb_9:
    ds_read_b64_tr_b16 v[64:65], v8 offset:32768
    ds_read_b64_tr_b16 v[66:67], v8 offset:33280
    buffer_load_dwordx4 a[0:3], v136, s[16:19], s78 offen sc1
    v_mfma_f32_16x16x32_bf16 v[28:31], v[20:23], v[80:83], v[28:31]
    v_mfma_f32_32x32x16_bf16 v[176:191], v[84:87], a[180:183], v[176:191]
    ds_read_b64_tr_b16 v[68:69], v8 offset:40960
    ds_read_b64_tr_b16 v[70:71], v8 offset:41472
    buffer_load_dwordx4 a[4:7], v136, s[16:19], s28 offen sc1
    v_mfma_f32_16x16x32_bf16 v[28:31], v[20:23], v[84:87], v[28:31]
    s_waitcnt lgkmcnt(4)
    v_mfma_f32_32x32x16_bf16 v[176:191], v[88:91], a[184:187], v[176:191]
    ds_read_b64_tr_b16 v[72:73], v9 offset:32768
    ds_read_b64_tr_b16 v[74:75], v9 offset:33280
    buffer_load_dwordx4 a[8:11], v137, s[16:19], s78 offen sc1
    v_mfma_f32_32x32x16_bf16 v[176:191], v[92:95], a[188:191], v[176:191]
    ds_read_b64_tr_b16 v[76:77], v9 offset:40960
    ds_read_b64_tr_b16 v[78:79], v9 offset:41472
    buffer_load_dwordx4 a[12:15], v137, s[16:19], s29 offen sc1
    s_waitcnt lgkmcnt(4)
    v_mfma_f32_32x32x16_bf16 v[176:191], v[64:67], a[192:195], v[176:191]
    ds_read_b64_tr_b16 v[80:81], v8 offset:33792
    ds_read_b64_tr_b16 v[82:83], v8 offset:34304
    buffer_load_dwordx4 a[16:19], v138, s[16:19], s78 offen sc1
    v_mfma_f32_16x16x32_bf16 v[28:31], v[20:23], v[64:67], v[28:31]
    v_mfma_f32_32x32x16_bf16 v[176:191], v[68:71], a[196:199], v[176:191]
    ds_read_b64_tr_b16 v[84:85], v8 offset:41984
    ds_read_b64_tr_b16 v[86:87], v8 offset:42496
    buffer_load_dwordx4 a[20:23], v138, s[16:19], s30 offen sc1
    v_mfma_f32_16x16x32_bf16 v[28:31], v[20:23], v[68:71], v[28:31]
    s_waitcnt lgkmcnt(4)
    v_mfma_f32_32x32x16_bf16 v[176:191], v[72:75], a[200:203], v[176:191]
    ds_read_b64_tr_b16 v[88:89], v9 offset:33792
    ds_read_b64_tr_b16 v[90:91], v9 offset:34304
    buffer_load_dwordx4 a[24:27], v139, s[16:19], s78 offen sc1
    v_mfma_f32_32x32x16_bf16 v[176:191], v[76:79], a[204:207], v[176:191]
    ds_read_b64_tr_b16 v[92:93], v9 offset:41984
    ds_read_b64_tr_b16 v[94:95], v9 offset:42496
    buffer_load_dwordx4 a[28:31], v139, s[16:19], s31 offen sc1
    s_waitcnt lgkmcnt(4)
    v_mfma_f32_32x32x16_bf16 v[176:191], v[80:83], a[208:211], v[176:191]
    ds_read_b64_tr_b16 v[64:65], v8 offset:49152
    ds_read_b64_tr_b16 v[66:67], v8 offset:49664
    buffer_load_dwordx4 a[32:35], v140, s[16:19], s78 offen sc1
    v_mfma_f32_16x16x32_bf16 v[28:31], v[20:23], v[80:83], v[28:31]
    v_mfma_f32_32x32x16_bf16 v[176:191], v[84:87], a[212:215], v[176:191]
    ds_read_b64_tr_b16 v[68:69], v8 offset:57344
    ds_read_b64_tr_b16 v[70:71], v8 offset:57856
    buffer_load_dwordx4 a[36:39], v140, s[16:19], s78 offen offset:1024 sc1
    v_mfma_f32_16x16x32_bf16 v[28:31], v[20:23], v[84:87], v[28:31]
    s_waitcnt lgkmcnt(4)
    v_mfma_f32_32x32x16_bf16 v[176:191], v[88:91], a[216:219], v[176:191]
    ds_read_b64_tr_b16 v[72:73], v9 offset:49152
    ds_read_b64_tr_b16 v[74:75], v9 offset:49664
    v_mfma_f32_32x32x16_bf16 v[176:191], v[92:95], a[220:223], v[176:191]
    ds_read_b64_tr_b16 v[76:77], v9 offset:57344
    ds_read_b64_tr_b16 v[78:79], v9 offset:57856
    s_waitcnt lgkmcnt(4)
    v_mfma_f32_32x32x16_bf16 v[176:191], v[64:67], a[224:227], v[176:191]
    s_waitcnt vmcnt(12)
    s_mov_b64 exec, 31
    buffer_atomic_add v113, v112, s[16:19], s59 offen offset:12 sc1
    s_mov_b64 exec, -1
    ds_read_b64_tr_b16 v[80:81], v8 offset:50176
    ds_read_b64_tr_b16 v[82:83], v8 offset:50688
    v_mfma_f32_16x16x32_bf16 v[28:31], v[20:23], v[64:67], v[28:31]
    v_mfma_f32_32x32x16_bf16 v[176:191], v[68:71], a[228:231], v[176:191]
    ds_read_b64_tr_b16 v[84:85], v8 offset:58368
    ds_read_b64_tr_b16 v[86:87], v8 offset:58880
    v_mfma_f32_16x16x32_bf16 v[28:31], v[20:23], v[68:71], v[28:31]
    s_waitcnt lgkmcnt(4)
    v_mfma_f32_32x32x16_bf16 v[176:191], v[72:75], a[232:235], v[176:191]
    ds_read_b64_tr_b16 v[88:89], v9 offset:50176
    ds_read_b64_tr_b16 v[90:91], v9 offset:50688
    v_mfma_f32_32x32x16_bf16 v[176:191], v[76:79], a[236:239], v[176:191]
    ds_read_b64_tr_b16 v[92:93], v9 offset:58368
    ds_read_b64_tr_b16 v[94:95], v9 offset:58880
    s_waitcnt lgkmcnt(4)
    v_mfma_f32_16x16x32_bf16 v[28:31], v[20:23], v[80:83], v[28:31]
    v_mfma_f32_16x16x32_bf16 v[28:31], v[20:23], v[84:87], v[28:31]
    v_mfma_f32_32x32x16_bf16 v[176:191], v[80:83], a[240:243], v[176:191]
    s_atomic_add s58, s[82:83], s55 offset:0
    s_nop 5
    ds_write_b32 v60, v28 offset:0
    v_mfma_f32_32x32x16_bf16 v[176:191], v[84:87], a[244:247], v[176:191]
    ds_read_b32 v253, v2
    s_waitcnt lgkmcnt(1)
    v_mfma_f32_32x32x16_bf16 v[176:191], v[88:91], a[248:251], v[176:191]
    s_barrier
    ds_read_b32 v18, v61 offset:0
    ds_read_b32 v253, v2
    v_mfma_f32_32x32x16_bf16 v[176:191], v[92:95], a[252:255], v[176:191]
    s_waitcnt lgkmcnt(1)
    v_add_f32 v28, v28, v18
    v_cvt_pk_bf16_f32 v18, v28, v28
    v_and_b32 v18, 0xffff0000, v18
    v_sub_f32 v48, v28, v18
    v_cvt_pk_bf16_f32 v48, v18, v48
    s_nop 1
    v_mfma_f32_32x32x16_bf16 v[176:191], v[48:51], v[44:47], v[176:191]
    v_add_u32 v4, 4096, v1
    s_lshl_b32 s42, s34, 8
    v_xor_b32 v5, s42, v1
    v_add_u32 v6, 4096, v5
    s_nop 7
    v_pk_mul_f32 v[176:177], v[176:177], v[56:57]
    v_pk_mul_f32 v[178:179], v[178:179], v[56:57]
    v_pk_mul_f32 v[180:181], v[180:181], v[56:57]
    v_pk_mul_f32 v[182:183], v[182:183], v[56:57]
    v_pk_mul_f32 v[184:185], v[184:185], v[56:57]
    v_pk_mul_f32 v[186:187], v[186:187], v[56:57]
    v_pk_mul_f32 v[188:189], v[188:189], v[56:57]
    v_pk_mul_f32 v[190:191], v[190:191], v[56:57]
    v_cvt_pk_bf16_f32 v176, v176, v177
    v_cvt_pk_bf16_f32 v177, v178, v179
    v_cvt_pk_bf16_f32 v178, v180, v181
    v_cvt_pk_bf16_f32 v179, v182, v183
    v_cvt_pk_bf16_f32 v180, v184, v185
    v_cvt_pk_bf16_f32 v181, v186, v187
    v_cvt_pk_bf16_f32 v182, v188, v189
    v_cvt_pk_bf16_f32 v183, v190, v191
    ds_write_b128 v141, v[176:179]
    ds_write_b128 v141, v[180:183] offset:2048
    ds_read_b32 v253, v2
    s_waitcnt lgkmcnt(1)
    s_barrier
    ds_read_b128 a[120:123], v142
    ds_read_b128 a[124:127], v142 offset:1024
    s_waitcnt lgkmcnt(0)
    s_waitcnt vmcnt(10)
    v_mfma_f32_32x32x16_bf16 v[112:127], a[0:3], a[120:123], v[224:239]
    s_waitcnt vmcnt(9)
    v_mfma_f32_32x32x16_bf16 v[128:143], a[4:7], a[120:123], 0
    s_waitcnt vmcnt(8)
    v_mfma_f32_32x32x16_bf16 v[144:159], a[8:11], a[120:123], 0
    s_mov_b32 s63, 0
    s_atomic_umax s63, s[82:83], s59 offset:12 glc
    s_nop 5
    v_max_f32 v16, v112, v113
    v_max3_f32 v16, v114, v115, v16
    v_max3_f32 v16, v116, v117, v16
    v_max3_f32 v16, v118, v119, v16
    v_max3_f32 v16, v120, v121, v16
    v_max3_f32 v16, v122, v123, v16
    v_max3_f32 v16, v124, v125, v16
    v_max3_f32 v16, v126, v127, v16
    s_waitcnt vmcnt(7)
    v_mfma_f32_32x32x16_bf16 v[112:127], a[12:15], a[120:123], 0
    v_max3_f32 v16, v128, v129, v16
    v_max3_f32 v16, v130, v131, v16
    v_max3_f32 v16, v132, v133, v16
    v_max3_f32 v16, v134, v135, v16
    v_max3_f32 v16, v136, v137, v16
    v_max3_f32 v16, v138, v139, v16
    v_max3_f32 v16, v140, v141, v16
    v_max3_f32 v16, v142, v143, v16
    s_waitcnt vmcnt(6)
    v_mfma_f32_32x32x16_bf16 v[128:143], a[16:19], a[120:123], 0
    v_max3_f32 v16, v144, v145, v16
    v_max3_f32 v16, v146, v147, v16
    v_max3_f32 v16, v148, v149, v16
    v_max3_f32 v16, v150, v151, v16
    v_max3_f32 v16, v152, v153, v16
    v_max3_f32 v16, v154, v155, v16
    v_max3_f32 v16, v156, v157, v16
    v_max3_f32 v16, v158, v159, v16
    s_waitcnt vmcnt(5)
    v_mfma_f32_32x32x16_bf16 v[144:159], a[20:23], a[120:123], 0
    v_max3_f32 v16, v112, v113, v16
    v_max3_f32 v16, v114, v115, v16
    v_max3_f32 v16, v116, v117, v16
    v_max3_f32 v16, v118, v119, v16
    v_max3_f32 v16, v120, v121, v16
    v_max3_f32 v16, v122, v123, v16
    v_max3_f32 v16, v124, v125, v16
    v_max3_f32 v16, v126, v127, v16
    s_waitcnt vmcnt(4)
    v_mfma_f32_32x32x16_bf16 v[112:127], a[24:27], a[120:123], 0
    v_max3_f32 v16, v128, v129, v16
    v_max3_f32 v16, v130, v131, v16
    v_max3_f32 v16, v132, v133, v16
    v_max3_f32 v16, v134, v135, v16
    v_max3_f32 v16, v136, v137, v16
    v_max3_f32 v16, v138, v139, v16
    v_max3_f32 v16, v140, v141, v16
    v_max3_f32 v16, v142, v143, v16
    s_waitcnt vmcnt(3)
    v_mfma_f32_32x32x16_bf16 v[128:143], a[28:31], a[120:123], 0
    v_max3_f32 v16, v144, v145, v16
    v_max3_f32 v16, v146, v147, v16
    v_max3_f32 v16, v148, v149, v16
    v_max3_f32 v16, v150, v151, v16
    v_max3_f32 v16, v152, v153, v16
    v_max3_f32 v16, v154, v155, v16
    v_max3_f32 v16, v156, v157, v16
    v_max3_f32 v16, v158, v159, v16
    s_waitcnt vmcnt(2)
    v_mfma_f32_32x32x16_bf16 v[144:159], a[32:35], a[120:123], v[208:223]
    v_max3_f32 v16, v112, v113, v16
    v_max3_f32 v16, v114, v115, v16
    v_max3_f32 v16, v116, v117, v16
    v_max3_f32 v16, v118, v119, v16
    v_max3_f32 v16, v120, v121, v16
    v_max3_f32 v16, v122, v123, v16
    v_max3_f32 v16, v124, v125, v16
    v_max3_f32 v16, v126, v127, v16
    v_mfma_f32_32x32x16_bf16 v[112:127], a[4:7], a[124:127], v[224:239]
    v_max3_f32 v16, v128, v129, v16
    v_max3_f32 v16, v130, v131, v16
    v_max3_f32 v16, v132, v133, v16
    v_max3_f32 v16, v134, v135, v16
    v_max3_f32 v16, v136, v137, v16
    v_max3_f32 v16, v138, v139, v16
    v_max3_f32 v16, v140, v141, v16
    v_max3_f32 v16, v142, v143, v16
    v_mfma_f32_32x32x16_bf16 v[128:143], a[8:11], a[124:127], 0
    v_max3_f32 v16, v144, v145, v16
    v_max3_f32 v16, v146, v147, v16
    v_max3_f32 v16, v148, v149, v16
    v_max3_f32 v16, v150, v151, v16
    v_max3_f32 v16, v152, v153, v16
    v_max3_f32 v16, v154, v155, v16
    v_max3_f32 v16, v156, v157, v16
    v_max3_f32 v16, v158, v159, v16
    v_mfma_f32_32x32x16_bf16 v[144:159], a[12:15], a[124:127], 0
    v_mov_b32 v18, v16
    v_max_f32 v17, v112, v113
    s_nop 0
    v_permlane32_swap_b32 v16, v18
    v_max3_f32 v17, v114, v115, v17
    v_max_f32 v16, v16, v18
    v_max3_f32 v17, v116, v117, v17
    v_and_b32 v18, 0xffff0000, v16
    v_max3_f32 v17, v118, v119, v17
    v_sub_f32 v18, v16, v18
    v_max3_f32 v17, v120, v121, v17
    v_and_b32 v19, 0xffff0000, v18
    v_max3_f32 v17, v122, v123, v17
    v_perm_b32 v244, v18, v16, s69
    v_max3_f32 v17, v124, v125, v17
    v_sub_f32 v245, v18, v19
    v_max3_f32 v17, v126, v127, v17
    v_mfma_f32_32x32x16_bf16 v[112:127], a[16:19], a[124:127], 0
    s_cmp_ge_u32 s63, s67
    s_cbranch_scc0 ps_10
pb_11:
    v_max3_f32 v17, v128, v129, v17
    v_max3_f32 v17, v130, v131, v17
    v_max3_f32 v17, v132, v133, v17
    s_mov_b64 exec, s[100:101]
    buffer_load_dwordx4 a[40:43], v248, s[16:19], s79 offen offset:0 sc1
    buffer_load_dwordx4 a[44:47], v248, s[16:19], s79 offen offset:512 sc1
    s_mov_b64 exec, -1
    v_max3_f32 v17, v134, v135, v17
    v_max3_f32 v17, v136, v137, v17
    v_max3_f32 v17, v138, v139, v17
    v_mfma_f32_32x32x16_bf16 v[44:59], v[240:243], v[244:247], v[224:239]
    v_max3_f32 v17, v140, v141, v17
    v_max3_f32 v17, v142, v143, v17
    v_mfma_f32_32x32x16_bf16 v[128:143], a[20:23], a[124:127], 0
    s_mov_b64 exec, s[100:101]
    buffer_load_dwordx4 a[48:51], v248, s[16:19], s79 offen offset:1024 sc1
    buffer_load_dwordx4 a[52:55], v248, s[16:19], s79 offen offset:1536 sc1
    s_mov_b64 exec, -1
    v_max3_f32 v17, v144, v145, v17
    v_max3_f32 v17, v146, v147, v17
    v_max3_f32 v17, v148, v149, v17
    v_max3_f32 v17, v150, v151, v17
    v_mfma_f32_32x32x16_bf16 v[192:207], v[240:243], v[244:247], 0
    v_max3_f32 v17, v152, v153, v17
    v_max3_f32 v17, v154, v155, v17
    v_max3_f32 v17, v156, v157, v17
    v_max3_f32 v17, v158, v159, v17
    v_mfma_f32_32x32x16_bf16 v[144:159], a[24:27], a[124:127], 0
    s_mov_b64 exec, s[100:101]
    buffer_load_dwordx4 a[56:59], v249, s[16:19], s79 offen offset:0 sc1
    buffer_load_dwordx4 a[60:63], v249, s[16:19], s79 offen offset:512 sc1
    s_mov_b64 exec, -1
    v_max3_f32 v17, v112, v113, v17
    v_max3_f32 v17, v114, v115, v17
    v_max3_f32 v17, v116, v117, v17
    v_max3_f32 v17, v118, v119, v17
    v_mfma_f32_32x32x16_bf16 v[28:43], v[240:243], v[244:247], v[208:223]
    v_max3_f32 v17, v120, v121, v17
    v_max3_f32 v17, v122, v123, v17
    v_max3_f32 v17, v124, v125, v17
    v_max3_f32 v17, v126, v127, v17
    v_mfma_f32_32x32x16_bf16 v[112:127], a[28:31], a[124:127], 0
    s_mov_b64 exec, s[100:101]
    buffer_load_dwordx4 a[64:67], v249, s[16:19], s79 offen offset:1024 sc1
    buffer_load_dwordx4 a[68:71], v249, s[16:19], s79 offen offset:1536 sc1
    s_mov_b64 exec, -1
    v_max3_f32 v17, v128, v129, v17
    v_max3_f32 v17, v130, v131, v17
    v_max3_f32 v17, v132, v133, v17
    v_max3_f32 v17, v134, v135, v17
    v_max3_f32 v17, v136, v137, v17
    v_max3_f32 v17, v138, v139, v17
    v_max3_f32 v17, v140, v141, v17
    v_max3_f32 v17, v142, v143, v17
    v_mfma_f32_32x32x16_bf16 v[128:143], a[32:35], a[124:127], 0
    s_mov_b64 exec, s[100:101]
    buffer_load_dwordx4 a[72:75], v250, s[16:19], s79 offen offset:0 sc1
    buffer_load_dwordx4 a[76:79], v250, s[16:19], s79 offen offset:512 sc1
    s_mov_b64 exec, -1
    v_max3_f32 v17, v144, v145, v17
    v_max3_f32 v17, v146, v147, v17
    v_max3_f32 v17, v148, v149, v17
    v_max3_f32 v17, v150, v151, v17
    v_max3_f32 v17, v152, v153, v17
    v_max3_f32 v17, v154, v155, v17
    v_max3_f32 v17, v156, v157, v17
    v_max3_f32 v17, v158, v159, v17
    s_waitcnt vmcnt(11)
    v_mfma_f32_32x32x16_bf16 v[144:159], a[36:39], a[124:127], v[208:223]
    s_mov_b64 exec, s[100:101]
    buffer_load_dwordx4 a[80:83], v250, s[16:19], s79 offen offset:1024 sc1
    buffer_load_dwordx4 a[84:87], v250, s[16:19], s79 offen offset:1536 sc1
    s_mov_b64 exec, -1
    v_max3_f32 v17, v112, v113, v17
    v_max3_f32 v17, v114, v115, v17
    v_max3_f32 v17, v116, v117, v17
    v_max3_f32 v17, v118, v119, v17
    v_max3_f32 v17, v120, v121, v17
    v_max3_f32 v17, v122, v123, v17
    v_max3_f32 v17, v124, v125, v17
    v_max3_f32 v17, v126, v127, v17
    v_mfma_f32_32x32x16_bf16 v[112:127], a[0:3], a[120:123], v[44:59]
    s_mov_b64 exec, s[100:101]
    buffer_load_dwordx4 a[88:91], v251, s[16:19], s79 offen offset:0 sc1
    buffer_load_dwordx4 a[92:95], v251, s[16:19], s79 offen offset:512 sc1
    s_mov_b64 exec, -1
    v_max3_f32 v17, v128, v129, v17
    v_max3_f32 v17, v130, v131, v17
    v_max3_f32 v17, v132, v133, v17
    v_max3_f32 v17, v134, v135, v17
    s_mov_b64 exec, 15
    buffer_load_dword v109, v110, s[16:19], 0 offen sc1
    s_mov_b64 exec, -1
    v_max3_f32 v17, v136, v137, v17
    v_max3_f32 v17, v138, v139, v17
    v_max3_f32 v17, v140, v141, v17
    v_max3_f32 v17, v142, v143, v17
    v_mfma_f32_32x32x16_bf16 v[128:143], a[4:7], a[120:123], v[192:207]
    s_mov_b64 exec, s[100:101]
    buffer_load_dwordx4 a[96:99], v251, s[16:19], s79 offen offset:1024 sc1
    buffer_load_dwordx4 a[100:103], v251, s[16:19], s79 offen offset:1536 sc1
    s_mov_b64 exec, -1
    v_max3_f32 v17, v144, v145, v17
    v_max3_f32 v17, v146, v147, v17
    v_max3_f32 v17, v148, v149, v17
    v_max3_f32 v17, v150, v151, v17
    v_max3_f32 v17, v152, v153, v17
    v_max3_f32 v17, v154, v155, v17
    v_max3_f32 v17, v156, v157, v17
    v_max3_f32 v17, v158, v159, v17
    v_exp_f32 v112, v112
    s_mov_b64 exec, s[100:101]
    buffer_load_dwordx4 a[104:107], v252, s[16:19], s79 offen offset:0 sc1
    buffer_load_dwordx4 a[108:111], v252, s[16:19], s79 offen offset:512 sc1
    s_mov_b64 exec, -1
    v_exp_f32 v113, v113
    v_exp_f32 v114, v114
    v_mov_b32 v18, v17
    v_cvt_pk_bf16_f32 v8, v112, v113
    v_exp_f32 v115, v115
    v_exp_f32 v116, v116
    v_permlane32_swap_b32 v17, v18
    v_cvt_pk_bf16_f32 v9, v114, v115
    v_exp_f32 v117, v117
    v_mfma_f32_32x32x16_bf16 v[144:159], a[8:11], a[120:123], v[192:207]
    v_max_f32 v17, v17, v18
    v_exp_f32 v118, v118
    v_cvt_pk_bf16_f32 v10, v116, v117
    v_exp_f32 v119, v119
    v_and_b32 v18, 0xffff0000, v17
    v_exp_f32 v120, v120
    v_cvt_pk_bf16_f32 v11, v118, v119
    v_exp_f32 v121, v121
    v_sub_f32 v18, v17, v18
    v_exp_f32 v122, v122
    s_waitcnt vmcnt(17)
    v_mfma_f32_32x32x16_bf16 v[160:175], a[40:43], v[8:11], 0
    v_cvt_pk_bf16_f32 v12, v120, v121
    v_and_b32 v19, 0xffff0000, v18
    v_exp_f32 v123, v123
    v_exp_f32 v124, v124
    v_cvt_pk_bf16_f32 v13, v122, v123
    v_perm_b32 v244, v18, v17, s69
    v_exp_f32 v125, v125
    v_exp_f32 v126, v126
    v_exp_f32 v127, v127
    v_sub_f32 v245, v18, v19
    v_cvt_pk_bf16_f32 v14, v124, v125
    v_cvt_pk_bf16_f32 v15, v126, v127
    v_exp_f32 v128, v128
    s_mov_b64 exec, s[100:101]
    buffer_load_dwordx4 a[112:115], v252, s[16:19], s79 offen offset:1024 sc1
    buffer_load_dwordx4 a[116:119], v252, s[16:19], s79 offen offset:1536 sc1
    s_mov_b64 exec, -1
    v_exp_f32 v129, v129
    v_mfma_f32_32x32x16_bf16 v[160:175], a[44:47], v[12:15], v[160:175]
    v_exp_f32 v130, v130
    v_cvt_pk_bf16_f32 v8, v128, v129
    v_exp_f32 v131, v131
    v_exp_f32 v132, v132
    v_cvt_pk_bf16_f32 v9, v130, v131
    v_exp_f32 v133, v133
    v_mfma_f32_32x32x16_bf16 v[112:127], a[12:15], a[120:123], v[192:207]
    v_exp_f32 v134, v134
    v_cvt_pk_bf16_f32 v10, v132, v133
    v_exp_f32 v135, v135
    v_exp_f32 v136, v136
    v_mfma_f32_32x32x16_bf16 v[44:59], v[240:243], v[244:247], v[224:239]
    v_cvt_pk_bf16_f32 v11, v134, v135
    v_exp_f32 v137, v137
    v_exp_f32 v138, v138
    s_waitcnt vmcnt(17)
    v_mfma_f32_32x32x16_bf16 v[160:175], a[48:51], v[8:11], v[160:175]
    v_cvt_pk_bf16_f32 v12, v136, v137
    v_exp_f32 v139, v139
    v_exp_f32 v140, v140
    v_cvt_pk_bf16_f32 v13, v138, v139
    v_exp_f32 v141, v141
    v_exp_f32 v142, v142
    v_exp_f32 v143, v143
    v_cvt_pk_bf16_f32 v14, v140, v141
    v_cvt_pk_bf16_f32 v15, v142, v143
    v_exp_f32 v144, v144
    v_exp_f32 v145, v145
    v_mfma_f32_32x32x16_bf16 v[160:175], a[52:55], v[12:15], v[160:175]
    v_exp_f32 v146, v146
    ds_read_b64_tr_b16 v[72:73], v254 offset:0
    v_cvt_pk_bf16_f32 v8, v144, v145
    v_exp_f32 v147, v147
    v_exp_f32 v148, v148
    ds_read_b64_tr_b16 v[74:75], v254 offset:1024
    v_cvt_pk_bf16_f32 v9, v146, v147
    v_exp_f32 v149, v149
    v_mfma_f32_32x32x16_bf16 v[128:143], a[16:19], a[120:123], v[192:207]
    v_exp_f32 v150, v150
    ds_read_b64_tr_b16 v[76:77], v255 offset:0
    v_cvt_pk_bf16_f32 v10, v148, v149
    v_exp_f32 v151, v151
    v_exp_f32 v152, v152
    ds_read_b64_tr_b16 v[78:79], v255 offset:1024
    v_cvt_pk_bf16_f32 v11, v150, v151
    v_exp_f32 v153, v153
    v_exp_f32 v154, v154
    s_waitcnt vmcnt(6)
    v_cmp_lt_u32 vcc, v109, v111
    s_and_b32 s57, vcc_lo, 15
    s_cbranch_scc1 gs_12
gb_13:
    s_barrier
    v_mfma_f32_32x32x16_bf16 v[160:175], a[56:59], v[8:11], v[160:175]
    v_cvt_pk_bf16_f32 v12, v152, v153
    v_exp_f32 v155, v155
    v_exp_f32 v156, v156
    buffer_load_dwordx4 a[128:131], v5, s[16:19], s74 offen offset:0 sc1
    v_cvt_pk_bf16_f32 v13, v154, v155
    v_exp_f32 v157, v157
    v_exp_f32 v158, v158
    buffer_load_dwordx4 a[132:135], v5, s[16:19], s75 offen offset:0 sc1
    v_exp_f32 v159, v159
    v_cvt_pk_bf16_f32 v14, v156, v157
    v_cvt_pk_bf16_f32 v15, v158, v159
    v_exp_f32 v112, v112
    s_waitcnt lgkmcnt(0)
    v_exp_f32 v113, v113
    v_mfma_f32_32x32x16_bf16 v[160:175], a[60:63], v[12:15], v[160:175]
    v_exp_f32 v114, v114
    v_cvt_pk_bf16_f32 v8, v112, v113
    buffer_store_dwordx4 v[72:75], v1, s[16:19], s88 offen sc1
    v_exp_f32 v115, v115
    v_exp_f32 v116, v116
    v_cvt_pk_bf16_f32 v9, v114, v115
    v_exp_f32 v117, v117
    v_mfma_f32_32x32x16_bf16 v[144:159], a[20:23], a[120:123], v[192:207]
    buffer_store_dwordx4 v[76:79], v1, s[16:19], s89 offen sc1
    v_exp_f32 v118, v118
    v_cvt_pk_bf16_f32 v10, v116, v117
    v_exp_f32 v119, v119
    v_exp_f32 v120, v120
    buffer_load_dwordx4 a[136:139], v5, s[16:19], s74 offen offset:1024 sc1
    v_cvt_pk_bf16_f32 v11, v118, v119
    v_exp_f32 v121, v121
    v_exp_f32 v122, v122
    v_mfma_f32_32x32x16_bf16 v[160:175], a[64:67], v[8:11], v[160:175]
    v_cvt_pk_bf16_f32 v12, v120, v121
    buffer_load_dwordx4 a[140:143], v5, s[16:19], s75 offen offset:1024 sc1
    v_exp_f32 v123, v123
    v_exp_f32 v124, v124
    v_cvt_pk_bf16_f32 v13, v122, v123
    v_exp_f32 v125, v125
    buffer_load_dwordx4 a[144:147], v5, s[16:19], s74 offen offset:2048 sc1
    v_exp_f32 v126, v126
    v_exp_f32 v127, v127
    v_cvt_pk_bf16_f32 v14, v124, v125
    v_cvt_pk_bf16_f32 v15, v126, v127
    v_exp_f32 v128, v128
    s_lshl_b32 s47, s3, 1
    v_exp_f32 v129, v129
    v_mfma_f32_32x32x16_bf16 v[160:175], a[68:71], v[12:15], v[160:175]
    v_xor_b32 v60, s47, v0
    v_exp_f32 v130, v130
    v_cvt_pk_bf16_f32 v8, v128, v129
    v_and_b32 v60, 7, v60
    v_exp_f32 v131, v131
    v_exp_f32 v132, v132
    v_lshrrev_b32 v61, 5, v0
    v_cvt_pk_bf16_f32 v9, v130, v131
    v_exp_f32 v133, v133
    v_lshl_add_u32 v60, v60, 1, v61
    v_mfma_f32_32x32x16_bf16 v[112:127], a[24:27], a[120:123], v[192:207]
    v_exp_f32 v134, v134
    v_and_b32 v61, 31, v0
    v_cvt_pk_bf16_f32 v10, v132, v133
    v_exp_f32 v135, v135
    v_lshl_add_u32 v60, v61, 4, v60
    v_exp_f32 v136, v136
    v_cvt_pk_bf16_f32 v11, v134, v135
    v_mov_b32 v61, 139264
    v_exp_f32 v137, v137
    v_exp_f32 v138, v138
    v_lshl_add_u32 v60, v60, 3, v61
    v_mfma_f32_32x32x16_bf16 v[160:175], a[72:75], v[8:11], v[160:175]
    v_cvt_pk_bf16_f32 v12, v136, v137
    v_xor_b32 v61, 16, v60
    v_exp_f32 v139, v139
    v_exp_f32 v140, v140
    buffer_load_dwordx4 a[148:151], v5, s[16:19], s75 offen offset:2048 sc1
    v_cvt_pk_bf16_f32 v13, v138, v139
    v_exp_f32 v141, v141
    buffer_load_dwordx4 a[152:155], v5, s[16:19], s74 offen offset:3072 sc1
    v_exp_f32 v142, v142
    v_exp_f32 v143, v143
    buffer_load_dwordx4 a[156:159], v5, s[16:19], s75 offen offset:3072 sc1
    v_cvt_pk_bf16_f32 v14, v140, v141
    v_cvt_pk_bf16_f32 v15, v142, v143
    v_exp_f32 v144, v144
    ds_read_b64 v[24:25], v60 offset:0
    v_exp_f32 v145, v145
    v_mfma_f32_32x32x16_bf16 v[160:175], a[76:79], v[12:15], v[160:175]
    v_exp_f32 v146, v146
    ds_read_b64 v[26:27], v61 offset:0
    v_cvt_pk_bf16_f32 v8, v144, v145
    v_exp_f32 v147, v147
    v_exp_f32 v148, v148
    v_cvt_pk_bf16_f32 v9, v146, v147
    ds_read_b64 v[248:249], v60 offset:4096
    v_exp_f32 v149, v149
    v_mfma_f32_32x32x16_bf16 v[128:143], a[28:31], a[120:123], v[192:207]
    v_exp_f32 v150, v150
    v_cvt_pk_bf16_f32 v10, v148, v149
    ds_read_b64 v[250:251], v61 offset:4096
    v_exp_f32 v151, v151
    v_exp_f32 v152, v152
    v_cvt_pk_bf16_f32 v11, v150, v151
    v_exp_f32 v153, v153
    buffer_load_dwordx4 a[160:163], v6, s[16:19], s74 offen offset:0 sc1
    v_exp_f32 v154, v154
    v_mfma_f32_32x32x16_bf16 v[160:175], a[80:83], v[8:11], v[160:175]
    v_cvt_pk_bf16_f32 v12, v152, v153
    v_exp_f32 v155, v155
    buffer_load_dwordx4 a[164:167], v6, s[16:19], s75 offen offset:0 sc1
    v_exp_f32 v156, v156
    v_cvt_pk_bf16_f32 v13, v154, v155
    v_exp_f32 v157, v157
    v_exp_f32 v158, v158
    buffer_load_dwordx4 a[168:171], v6, s[16:19], s74 offen offset:1024 sc1
    v_exp_f32 v159, v159
    v_cvt_pk_bf16_f32 v14, v156, v157
    v_cvt_pk_bf16_f32 v15, v158, v159
    v_exp_f32 v112, v112
    v_mfma_f32_32x32x16_bf16 v[192:207], v[240:243], v[244:247], 0
    v_exp_f32 v113, v113
    v_mfma_f32_32x32x16_bf16 v[160:175], a[84:87], v[12:15], v[160:175]
    v_exp_f32 v114, v114
    v_cvt_pk_bf16_f32 v8, v112, v113
    v_exp_f32 v115, v115
    v_exp_f32 v116, v116
    buffer_load_dwordx4 a[172:175], v6, s[16:19], s75 offen offset:1024 sc1
    v_cvt_pk_bf16_f32 v9, v114, v115
    v_exp_f32 v117, v117
    v_mfma_f32_32x32x16_bf16 v[144:159], a[32:35], a[120:123], v[28:43]
    v_exp_f32 v118, v118
    v_cvt_pk_bf16_f32 v10, v116, v117
    v_exp_f32 v119, v119
    v_exp_f32 v120, v120
    buffer_load_dwordx4 a[176:179], v6, s[16:19], s74 offen offset:2048 sc1
    v_cvt_pk_bf16_f32 v11, v118, v119
    v_exp_f32 v121, v121
    v_exp_f32 v122, v122
    v_mfma_f32_32x32x16_bf16 v[160:175], a[88:91], v[8:11], v[160:175]
    v_cvt_pk_bf16_f32 v12, v120, v121
    v_exp_f32 v123, v123
    v_exp_f32 v124, v124
    buffer_load_dwordx4 a[180:183], v6, s[16:19], s75 offen offset:2048 sc1
    v_cvt_pk_bf16_f32 v13, v122, v123
    v_exp_f32 v125, v125
    v_exp_f32 v126, v126
    v_exp_f32 v127, v127
    v_cvt_pk_bf16_f32 v14, v124, v125
    v_cvt_pk_bf16_f32 v15, v126, v127
    v_exp_f32 v128, v128
    ds_read_b32 v253, v2
    ds_read_b32 v253, v2
    s_waitcnt lgkmcnt(2)
    v_exp_f32 v129, v129
    v_mfma_f32_32x32x16_bf16 v[160:175], a[92:95], v[12:15], v[160:175]
    v_exp_f32 v130, v130
    v_cvt_pk_bf16_f32 v8, v128, v129
    v_exp_f32 v131, v131
    v_exp_f32 v132, v132
    buffer_load_dwordx4 a[184:187], v6, s[16:19], s74 offen offset:3072 sc1
    v_cvt_pk_bf16_f32 v9, v130, v131
    v_exp_f32 v133, v133
    v_mfma_f32_32x32x16_bf16 v[112:127], a[4:7], a[124:127], v[44:59]
    v_exp_f32 v134, v134
    v_cvt_pk_bf16_f32 v10, v132, v133
    v_exp_f32 v135, v135
    v_exp_f32 v136, v136
    buffer_load_dwordx4 a[188:191], v6, s[16:19], s75 offen offset:3072 sc1
    v_cvt_pk_bf16_f32 v11, v134, v135
    v_exp_f32 v137, v137
    v_exp_f32 v138, v138
    s_waitcnt vmcnt(22)
    v_mfma_f32_32x32x16_bf16 v[160:175], a[96:99], v[8:11], v[160:175]
    v_cvt_pk_bf16_f32 v12, v136, v137
    v_exp_f32 v139, v139
    v_exp_f32 v140, v140
    s_lshl_b32 s42, s32, 1
    v_lshrrev_b32 v106, 5, v0
    v_add_u32 v106, s42, v106
    v_min_u32 v106, 6, v106
    v_and_b32 v105, 15, v0
    v_lshl_add_u32 v105, v106, 4, v105
    v_bfe_u32 v107, v0, 4, 1
    v_mul_u32_u24 v107, 57344, v107
    v_lshl_add_u32 v105, v105, 2, v107
    v_cvt_pk_bf16_f32 v13, v138, v139
    v_exp_f32 v141, v141
    v_exp_f32 v142, v142
    v_exp_f32 v143, v143
    v_cvt_pk_bf16_f32 v14, v140, v141
    v_cvt_pk_bf16_f32 v15, v142, v143
    v_exp_f32 v144, v144
    v_mfma_f32_32x32x16_bf16 v[28:43], v[240:243], v[244:247], v[208:223]
    v_exp_f32 v145, v145
    v_mfma_f32_32x32x16_bf16 v[160:175], a[100:103], v[12:15], v[160:175]
    v_exp_f32 v146, v146
    v_cvt_pk_bf16_f32 v8, v144, v145
    v_exp_f32 v147, v147
    s_waitcnt vmcnt(14)
    s_atomic_add s58, s[82:83], s90 offset:0
    v_exp_f32 v148, v148
    v_cvt_pk_bf16_f32 v9, v146, v147
    v_exp_f32 v149, v149
    v_mfma_f32_32x32x16_bf16 v[128:143], a[8:11], a[124:127], v[192:207]
    v_exp_f32 v150, v150
    buffer_load_dword v64, v105, s[16:19], s87 offen sc1
    s_add_u32 s87, s87, 7168
    v_cvt_pk_bf16_f32 v10, v148, v149
    v_exp_f32 v151, v151
    v_exp_f32 v152, v152
    v_cvt_pk_bf16_f32 v11, v150, v151
    v_exp_f32 v153, v153
    v_exp_f32 v154, v154
    buffer_load_dword v65, v105, s[16:19], s87 offen sc1
    s_add_u32 s87, s87, 7168
    v_mfma_f32_32x32x16_bf16 v[160:175], a[104:107], v[8:11], v[160:175]
    v_cvt_pk_bf16_f32 v12, v152, v153
    v_exp_f32 v155, v155
    v_exp_f32 v156, v156
    v_cvt_pk_bf16_f32 v13, v154, v155
    buffer_load_dword v66, v105, s[16:19], s87 offen sc1
    s_add_u32 s87, s87, 7168
    v_exp_f32 v157, v157
    v_exp_f32 v158, v158
    v_exp_f32 v159, v159
    v_cvt_pk_bf16_f32 v14, v156, v157
    v_cvt_pk_bf16_f32 v15, v158, v159
    v_exp_f32 v112, v112
    v_exp_f32 v113, v113
    v_mfma_f32_32x32x16_bf16 v[160:175], a[108:111], v[12:15], v[160:175]
    v_exp_f32 v114, v114
    v_cvt_pk_bf16_f32 v8, v112, v113
    v_exp_f32 v115, v115
    v_exp_f32 v116, v116
    s_nop 7
    v_rcp_f32 v168, v168
    v_cvt_pk_bf16_f32 v9, v114, v115
    v_mul_f32 v160, v160, v168
    v_exp_f32 v117, v117
    v_mfma_f32_32x32x16_bf16 v[144:159], a[12:15], a[124:127], v[192:207]
    v_mul_f32 v161, v161, v168
    v_exp_f32 v118, v118
    v_mul_f32 v162, v162, v168
    v_cvt_pk_bf16_f32 v10, v116, v117
    v_mul_f32 v163, v163, v168
    v_exp_f32 v119, v119
    v_mul_f32 v164, v164, v168
    v_exp_f32 v120, v120
    v_mul_f32 v165, v165, v168
    v_cvt_pk_bf16_f32 v11, v118, v119
    v_mul_f32 v166, v166, v168
    v_exp_f32 v121, v121
    v_mul_f32 v167, v167, v168
    v_exp_f32 v122, v122
    v_cvt_pk_bf16_f32 v160, v160, v161
    v_mfma_f32_32x32x16_bf16 v[176:191], a[48:51], v[8:11], 0
    v_cvt_pk_bf16_f32 v12, v120, v121
    v_cvt_pk_bf16_f32 v161, v162, v163
    v_exp_f32 v123, v123
    v_cvt_pk_bf16_f32 v162, v164, v165
    v_exp_f32 v124, v124
    v_cvt_pk_bf16_f32 v163, v166, v167
    v_cvt_pk_bf16_f32 v13, v122, v123
    buffer_store_dwordx4 v[160:163], v1, s[16:19], s53 offen sc1
    v_exp_f32 v125, v125
    s_add_u32 s53, s53, 32768
    v_exp_f32 v126, v126
    buffer_load_dword v67, v105, s[16:19], s87 offen sc1
    s_add_u32 s87, s87, 7168
    v_exp_f32 v127, v127
    buffer_load_dword v68, v105, s[16:19], s87 offen sc1
    s_add_u32 s87, s87, 7168
    v_cvt_pk_bf16_f32 v14, v124, v125
    buffer_load_dword v69, v105, s[16:19], s87 offen sc1
    s_add_u32 s87, s87, 7168
    v_cvt_pk_bf16_f32 v15, v126, v127
    v_exp_f32 v128, v128
    buffer_load_dword v70, v105, s[16:19], s87 offen sc1
    s_add_u32 s87, s87, 7168
    v_exp_f32 v129, v129
    v_mfma_f32_32x32x16_bf16 v[176:191], a[52:55], v[12:15], v[176:191]
    v_exp_f32 v130, v130
    v_cvt_pk_bf16_f32 v8, v128, v129
    v_exp_f32 v131, v131
    v_exp_f32 v132, v132
    v_cvt_pk_bf16_f32 v9, v130, v131
    v_exp_f32 v133, v133
    v_mfma_f32_32x32x16_bf16 v[112:127], a[16:19], a[124:127], v[192:207]
    buffer_load_dword v71, v105, s[16:19], s87 offen sc1
    s_add_u32 s87, s87, 7168
    v_exp_f32 v134, v134
    v_cvt_pk_bf16_f32 v10, v132, v133
    v_exp_f32 v135, v135
    v_exp_f32 v136, v136
    v_cvt_pk_bf16_f32 v11, v134, v135
    v_exp_f32 v137, v137
    v_exp_f32 v138, v138
    v_mfma_f32_32x32x16_bf16 v[176:191], a[56:59], v[8:11], v[176:191]
    v_cvt_pk_bf16_f32 v12, v136, v137
    s_add_u32 m0, s61, 0
    s_add_u32 s85, s91, 0
    buffer_load_dwordx4 v1, s[16:19], s85 offen offset:0 sc1 lds
    v_exp_f32 v139, v139
    v_exp_f32 v140, v140
    v_cvt_pk_bf16_f32 v13, v138, v139
    v_exp_f32 v141, v141
    v_exp_f32 v142, v142
    v_exp_f32 v143, v143
    v_cvt_pk_bf16_f32 v14, v140, v141
    v_cvt_pk_bf16_f32 v15, v142, v143
    v_exp_f32 v144, v144
    buffer_load_dwordx4 v1, s[16:19], s85 offen offset:1024 sc1 lds
    v_exp_f32 v145, v145
    v_mfma_f32_32x32x16_bf16 v[176:191], a[60:63], v[12:15], v[176:191]
    v_exp_f32 v146, v146
    v_cvt_pk_bf16_f32 v8, v144, v145
    v_exp_f32 v147, v147
    v_exp_f32 v148, v148
    v_cvt_pk_bf16_f32 v9, v146, v147
    v_exp_f32 v149, v149
    v_mfma_f32_32x32x16_bf16 v[128:143], a[20:23], a[124:127], v[192:207]
    buffer_load_dwordx4 v1, s[16:19], s85 offen offset:2048 sc1 lds
    v_exp_f32 v150, v150
    v_cvt_pk_bf16_f32 v10, v148, v149
    v_exp_f32 v151, v151
    v_exp_f32 v152, v152
    v_cvt_pk_bf16_f32 v11, v150, v151
    v_exp_f32 v153, v153
    v_exp_f32 v154, v154
    v_mfma_f32_32x32x16_bf16 v[176:191], a[64:67], v[8:11], v[176:191]
    v_cvt_pk_bf16_f32 v12, v152, v153
    buffer_load_dwordx4 v1, s[16:19], s85 offen offset:3072 sc1 lds
    v_exp_f32 v155, v155
    v_exp_f32 v156, v156
    v_cvt_pk_bf16_f32 v13, v154, v155
    v_exp_f32 v157, v157
    v_exp_f32 v158, v158
    v_exp_f32 v159, v159
    v_cvt_pk_bf16_f32 v14, v156, v157
    v_cvt_pk_bf16_f32 v15, v158, v159
    v_exp_f32 v112, v112
    s_add_u32 m0, s61, 16384
    s_add_u32 s85, s91, 16384
    buffer_load_dwordx4 v1, s[16:19], s85 offen offset:0 sc1 lds
    v_exp_f32 v113, v113
    v_mfma_f32_32x32x16_bf16 v[176:191], a[68:71], v[12:15], v[176:191]
    v_exp_f32 v114, v114
    v_cvt_pk_bf16_f32 v8, v112, v113
    v_exp_f32 v115, v115
    v_exp_f32 v116, v116
    v_cvt_pk_bf16_f32 v9, v114, v115
    v_exp_f32 v117, v117
    v_mfma_f32_32x32x16_bf16 v[144:159], a[24:27], a[124:127], v[192:207]
    buffer_load_dwordx4 v1, s[16:19], s85 offen offset:1024 sc1 lds
    v_exp_f32 v118, v118
    v_cvt_pk_bf16_f32 v10, v116, v117
    v_exp_f32 v119, v119
    v_exp_f32 v120, v120
    v_cvt_pk_bf16_f32 v11, v118, v119
    v_exp_f32 v121, v121
    v_exp_f32 v122, v122
    v_mfma_f32_32x32x16_bf16 v[176:191], a[72:75], v[8:11], v[176:191]
    v_cvt_pk_bf16_f32 v12, v120, v121
    buffer_load_dwordx4 v1, s[16:19], s85 offen offset:2048 sc1 lds
    v_exp_f32 v123, v123
    v_exp_f32 v124, v124
    v_cvt_pk_bf16_f32 v13, v122, v123
    v_exp_f32 v125, v125
    v_exp_f32 v126, v126
    v_exp_f32 v127, v127
    v_cvt_pk_bf16_f32 v14, v124, v125
    v_cvt_pk_bf16_f32 v15, v126, v127
    v_exp_f32 v128, v128
    buffer_load_dwordx4 v1, s[16:19], s85 offen offset:3072 sc1 lds
    v_exp_f32 v129, v129
    v_mfma_f32_32x32x16_bf16 v[176:191], a[76:79], v[12:15], v[176:191]
    v_exp_f32 v130, v130
    v_cvt_pk_bf16_f32 v8, v128, v129
    v_exp_f32 v131, v131
    v_exp_f32 v132, v132
    v_cvt_pk_bf16_f32 v9, v130, v131
    v_exp_f32 v133, v133
    v_mfma_f32_32x32x16_bf16 v[112:127], a[28:31], a[124:127], v[192:207]
    s_add_u32 m0, s61, 32768
    s_add_u32 s85, s91, 32768
    buffer_load_dwordx4 v1, s[16:19], s85 offen offset:0 sc1 lds
    v_exp_f32 v134, v134
    v_cvt_pk_bf16_f32 v10, v132, v133
    v_exp_f32 v135, v135
    v_exp_f32 v136, v136
    v_cvt_pk_bf16_f32 v11, v134, v135
    v_exp_f32 v137, v137
    v_exp_f32 v138, v138
    v_mfma_f32_32x32x16_bf16 v[176:191], a[80:83], v[8:11], v[176:191]
    v_cvt_pk_bf16_f32 v12, v136, v137
    buffer_load_dwordx4 v1, s[16:19], s85 offen offset:1024 sc1 lds
    v_exp_f32 v139, v139
    v_exp_f32 v140, v140
    v_cvt_pk_bf16_f32 v13, v138, v139
    v_exp_f32 v141, v141
    v_exp_f32 v142, v142
    v_exp_f32 v143, v143
    v_cvt_pk_bf16_f32 v14, v140, v141
    v_cvt_pk_bf16_f32 v15, v142, v143
    v_exp_f32 v144, v144
    s_waitcnt vmcnt(15)
    s_atomic_add s58, s[82:83], s71 offset:4
    v_exp_f32 v145, v145
    v_mfma_f32_32x32x16_bf16 v[176:191], a[84:87], v[12:15], v[176:191]
    v_exp_f32 v146, v146
    v_cvt_pk_bf16_f32 v8, v144, v145
    v_exp_f32 v147, v147
    v_exp_f32 v148, v148
    buffer_load_dwordx4 v1, s[16:19], s85 offen offset:2048 sc1 lds
    v_cvt_pk_bf16_f32 v9, v146, v147
    v_exp_f32 v149, v149
    v_mfma_f32_32x32x16_bf16 v[128:143], a[32:35], a[124:127], v[192:207]
    v_exp_f32 v150, v150
    v_cvt_pk_bf16_f32 v10, v148, v149
    v_exp_f32 v151, v151
    v_exp_f32 v152, v152
    buffer_load_dwordx4 v1, s[16:19], s85 offen offset:3072 sc1 lds
    v_cvt_pk_bf16_f32 v11, v150, v151
    v_exp_f32 v153, v153
    v_exp_f32 v154, v154
    v_mfma_f32_32x32x16_bf16 v[176:191], a[88:91], v[8:11], v[176:191]
    v_cvt_pk_bf16_f32 v12, v152, v153
    v_exp_f32 v155, v155
    v_exp_f32 v156, v156
    s_add_u32 m0, s61, 49152
    s_add_u32 s85, s91, 49152
    buffer_load_dwordx4 v1, s[16:19], s85 offen offset:0 sc1 lds
    v_cvt_pk_bf16_f32 v13, v154, v155
    v_exp_f32 v157, v157
    v_exp_f32 v158, v158
    v_exp_f32 v159, v159
    v_cvt_pk_bf16_f32 v14, v156, v157
    v_cvt_pk_bf16_f32 v15, v158, v159
    v_exp_f32 v112, v112
    buffer_load_dwordx4 v1, s[16:19], s85 offen offset:1024 sc1 lds
    v_exp_f32 v113, v113
    v_mfma_f32_32x32x16_bf16 v[176:191], a[92:95], v[12:15], v[176:191]
    v_exp_f32 v114, v114
    v_cvt_pk_bf16_f32 v8, v112, v113
    v_exp_f32 v115, v115
    v_exp_f32 v116, v116
    v_cvt_pk_bf16_f32 v9, v114, v115
    v_exp_f32 v117, v117
    v_mfma_f32_32x32x16_bf16 v[144:159], a[36:39], a[124:127], v[28:43]
    buffer_load_dwordx4 v1, s[16:19], s85 offen offset:2048 sc1 lds
    v_exp_f32 v118, v118
    v_cvt_pk_bf16_f32 v10, v116, v117
    v_exp_f32 v119, v119
    v_exp_f32 v120, v120
    v_cvt_pk_bf16_f32 v11, v118, v119
    v_exp_f32 v121, v121
    v_exp_f32 v122, v122
    v_mfma_f32_32x32x16_bf16 v[176:191], a[96:99], v[8:11], v[176:191]
    v_cvt_pk_bf16_f32 v12, v120, v121
    buffer_load_dwordx4 v1, s[16:19], s85 offen offset:3072 sc1 lds
    v_exp_f32 v123, v123
    v_exp_f32 v124, v124
    v_cvt_pk_bf16_f32 v13, v122, v123
    v_exp_f32 v125, v125
    v_exp_f32 v126, v126
    v_exp_f32 v127, v127
    v_cvt_pk_bf16_f32 v14, v124, v125
    v_cvt_pk_bf16_f32 v15, v126, v127
    v_exp_f32 v128, v128
    s_add_u32 m0, s61, 65536
    s_add_u32 s85, s91, 65536
    buffer_load_dwordx4 v1, s[16:19], s85 offen offset:0 sc1 lds
    v_exp_f32 v129, v129
    v_mfma_f32_32x32x16_bf16 v[176:191], a[100:103], v[12:15], v[176:191]
    v_exp_f32 v130, v130
    v_cvt_pk_bf16_f32 v8, v128, v129
    v_exp_f32 v131, v131
    v_exp_f32 v132, v132
    v_cvt_pk_bf16_f32 v9, v130, v131
    v_exp_f32 v133, v133
    buffer_load_dwordx4 v1, s[16:19], s85 offen offset:1024 sc1 lds
    v_exp_f32 v134, v134
    v_cvt_pk_bf16_f32 v10, v132, v133
    v_exp_f32 v135, v135
    v_exp_f32 v136, v136
    v_cvt_pk_bf16_f32 v11, v134, v135
    v_exp_f32 v137, v137
    v_exp_f32 v138, v138
    v_mfma_f32_32x32x16_bf16 v[176:191], a[104:107], v[8:11], v[176:191]
    v_cvt_pk_bf16_f32 v12, v136, v137
    buffer_load_dwordx4 v1, s[16:19], s85 offen offset:2048 sc1 lds
    v_exp_f32 v139, v139
    v_exp_f32 v140, v140
    v_cvt_pk_bf16_f32 v13, v138, v139
    v_exp_f32 v141, v141
    v_exp_f32 v142, v142
    v_exp_f32 v143, v143
    v_cvt_pk_bf16_f32 v14, v140, v141
    v_cvt_pk_bf16_f32 v15, v142, v143
    v_exp_f32 v144, v144
    buffer_load_dwordx4 v1, s[16:19], s85 offen offset:3072 sc1 lds
    v_exp_f32 v145, v145
    v_mfma_f32_32x32x16_bf16 v[176:191], a[108:111], v[12:15], v[176:191]
    v_exp_f32 v146, v146
    v_cvt_pk_bf16_f32 v8, v144, v145
    v_exp_f32 v147, v147
    v_exp_f32 v148, v148
    s_add_u32 m0, s61, 81920
    s_add_u32 s85, s91, 81920
    buffer_load_dwordx4 v1, s[16:19], s85 offen offset:0 sc1 lds
    v_cvt_pk_bf16_f32 v9, v146, v147
    v_exp_f32 v149, v149
    v_exp_f32 v150, v150
    v_cvt_pk_bf16_f32 v10, v148, v149
    v_exp_f32 v151, v151
    v_exp_f32 v152, v152
    buffer_load_dwordx4 v1, s[16:19], s85 offen offset:1024 sc1 lds
    v_cvt_pk_bf16_f32 v11, v150, v151
    v_exp_f32 v153, v153
    v_exp_f32 v154, v154
    v_mfma_f32_32x32x16_bf16 v[176:191], a[112:115], v[8:11], v[176:191]
    v_cvt_pk_bf16_f32 v12, v152, v153
    v_exp_f32 v155, v155
    v_exp_f32 v156, v156
    s_mov_b64 exec, 16
    buffer_load_dword v109, v110, s[16:19], 0 offen sc1
    s_mov_b64 exec, -1
    v_cvt_pk_bf16_f32 v13, v154, v155
    v_exp_f32 v157, v157
    v_exp_f32 v158, v158
    v_exp_f32 v159, v159
    v_cvt_pk_bf16_f32 v14, v156, v157
    v_cvt_pk_bf16_f32 v15, v158, v159
    s_nop 1
    v_mfma_f32_32x32x16_bf16 v[176:191], a[116:119], v[12:15], v[176:191]
    v_mov_b32 v120, 0
    v_lshlrev_b32 v112, 16, v24
    v_and_b32 v113, 0xffff0000, v24
    v_mov_b32 v121, 0
    v_mov_b32 v122, 0
    v_lshlrev_b32 v114, 16, v25
    v_and_b32 v115, 0xffff0000, v25
    v_mov_b32 v123, 0
    v_mov_b32 v124, 0
    v_lshlrev_b32 v116, 16, v26
    v_and_b32 v117, 0xffff0000, v26
    v_mov_b32 v125, 0
    v_mov_b32 v126, 0
    v_lshlrev_b32 v118, 16, v27
    v_and_b32 v119, 0xffff0000, v27
    v_mov_b32 v127, 0
    v_rcp_f32 v184, v184
    s_nop 0
    v_mul_f32 v176, v176, v184
    v_mul_f32 v177, v177, v184
    v_mul_f32 v178, v178, v184
    v_mul_f32 v179, v179, v184
    v_mul_f32 v180, v180, v184
    v_mul_f32 v181, v181, v184
    v_mul_f32 v182, v182, v184
    v_mul_f32 v183, v183, v184
    v_cvt_pk_bf16_f32 v176, v176, v177
    v_cvt_pk_bf16_f32 v177, v178, v179
    v_cvt_pk_bf16_f32 v178, v180, v181
    v_cvt_pk_bf16_f32 v179, v182, v183
    buffer_store_dwordx4 v[176:179], v1, s[16:19], s53 offen sc1
    s_mov_b32 s62, 0
    s_atomic_umax s62, s[82:83], s72 offset:4 glc
    buffer_load_dwordx4 v1, s[16:19], s85 offen offset:2048 sc1 lds
    s_lshl_b32 s42, s32, 11
    s_add_u32 s42, s42, 90112
    v_add_u32 v20, s42, v1
    v_xor_b32 v21, 2048, v20
    v_xor_b32 v22, 4096, v20
    v_xor_b32 v23, 6144, v20
    s_lshl_b32 s43, s32, 8
    s_add_u32 s43, s43, 159744
    v_lshl_add_u32 v14, v0, 2, s43
    buffer_load_dwordx4 v1, s[16:19], s85 offen offset:3072 sc1 lds
    s_mov_b32 s20, s76
    s_and_b32 s21, s77, 0xffff
    s_mov_b32 s22, 2097152
    s_xor_b32 s46, s33, 0
    s_lshl1_add_u32 s46, s38, s46
    s_lshl2_add_u32 s46, s46, s32
    s_mul_i32 s46, s46, 28672
    s_lshl_b32 s47, s34, 8
    s_add_u32 s46, s46, s47
    s_add_u32 m0, s61, 98304
    s_add_u32 s85, s91, 98304
    buffer_load_dwordx4 v1, s[16:19], s85 offen offset:0 sc1 lds
    s_add_u32 s8, s46, 11534336
    s_xor_b32 s9, s8, 256
    s_add_u32 s10, s46, 11548672
    s_xor_b32 s11, s10, 256
    s_xor_b32 s46, s33, 1
    s_lshl1_add_u32 s46, s38, s46
    s_lshl2_add_u32 s46, s46, s32
    s_mul_i32 s46, s46, 28672
    s_lshl_b32 s47, s34, 8
    buffer_load_dwordx4 v1, s[16:19], s85 offen offset:1024 sc1 lds
    s_add_u32 s46, s46, s47
    s_add_u32 s12, s46, 11534336
    s_xor_b32 s13, s12, 256
    s_add_u32 s14, s46, 11548672
    s_xor_b32 s15, s14, 256
    s_lshl3_add_u32 s46, s37, s32
    s_mul_i32 s46, s46, 28672
    s_add_u32 s92, s46, 17825792
    s_add_u32 s93, s46, 17826048
    buffer_load_dwordx4 v1, s[16:19], s85 offen offset:2048 sc1 lds
    s_add_u32 s94, s46, 17840128
    s_add_u32 s95, s46, 17840384
    s_add_u32 s96, s46, 17940480
    s_add_u32 s97, s46, 17940736
    s_add_u32 s98, s46, 17954816
    s_add_u32 s99, s46, 17955072
    s_lshl_b32 s46, s37, 6
    s_add_u32 s46, s46, s3
    s_lshl_b32 s46, s46, 10
    buffer_load_dwordx4 v1, s[16:19], s85 offen offset:3072 sc1 lds
    s_add_u32 s24, s46, 7340032
    s_lshl_b32 s25, s37, 8
    s_lshl1_add_u32 s46, s37, s33
    s_lshl3_add_u32 s46, s46, s38
    s_lshl_b32 s46, s46, 8
    s_add_u32 s30, s46, 9437184
    s_lshl2_add_u32 s46, s39, s32
    s_lshl_b32 s26, s46, 7
    s_lshl_b32 s47, s46, 15
    s_add_u32 m0, s61, 114688
    s_add_u32 s85, s91, 114688
    buffer_load_dwordx4 v1, s[16:19], s85 offen offset:0 sc1 lds
    s_add_u32 s27, s47, 7340032
    s_lshl_b32 s47, s46, 11
    s_add_u32 s31, s47, 9437184
    s_lshl4_add_u32 s47, s46, s40
    s_mul_i32 s47, s47, 7168
    s_add_u32 s28, s47, 17825792
    s_lshr_b32 s46, s46, 1
    s_lshr_b32 s47, s40, 2
    s_lshl2_add_u32 s46, s46, s47
    buffer_load_dwordx4 v1, s[16:19], s85 offen offset:1024 sc1 lds
    s_lshl_b32 s29, s46, 7
    v_mov_b32 v152, 0
    v_lshlrev_b32 v144, 16, v248
    v_and_b32 v145, 0xffff0000, v248
    v_mov_b32 v153, 0
    v_mov_b32 v154, 0
    v_lshlrev_b32 v146, 16, v249
    v_and_b32 v147, 0xffff0000, v249
    v_mov_b32 v155, 0
    buffer_load_dwordx4 v1, s[16:19], s85 offen offset:2048 sc1 lds
    v_mov_b32 v156, 0
    v_lshlrev_b32 v148, 16, v250
    v_and_b32 v149, 0xffff0000, v250
    v_mov_b32 v157, 0
    v_mov_b32 v158, 0
    v_lshlrev_b32 v150, 16, v251
    v_and_b32 v151, 0xffff0000, v251
    v_mov_b32 v159, 0
    s_cmp_ge_u32 s62, 8
    s_cbranch_scc0 ps_15
pb_16:
    buffer_load_dwordx4 v[208:211], v1, s[16:19], s73 offen offset:0 sc1
    buffer_load_dwordx4 v[212:215], v1, s[16:19], s73 offen offset:1024 sc1
    buffer_load_dwordx4 v[216:219], v1, s[16:19], s73 offen offset:2048 sc1
    s_waitcnt vmcnt(12)
    s_cmp_lg_u32 s71, -1
    s_cbranch_scc0 ow_17
    s_atomic_add s58, s[82:83], s71 offset:16388
ow_17:
    buffer_load_dwordx4 v[220:223], v1, s[16:19], s73 offen offset:3072 sc1
    buffer_load_dwordx4 v[224:227], v4, s[16:19], s73 offen offset:0 sc1
    buffer_load_dwordx4 v[228:231], v4, s[16:19], s73 offen offset:1024 sc1
    buffer_load_dwordx4 v[232:235], v4, s[16:19], s73 offen offset:2048 sc1
    buffer_load_dwordx4 v[236:239], v4, s[16:19], s73 offen offset:3072 sc1
    s_add_u32 s73, s73, 32768
    buffer_load_dwordx4 v1, s[16:19], s85 offen offset:3072 sc1 lds
    v_cmp_lt_u32 vcc, v109, v111
    s_and_b32 s57, vcc_lo, 16
    s_cbranch_scc1 gs_18
gb_19:
    v_lshrrev_b32 v6, 5, v0
    v_mul_u32_u24 v6, 6656, v6
    v_and_b32 v5, 256, v1
    v_add3_u32 v5, v5, v6, v1
    v_add_u32 v6, 4096, v5
    buffer_load_dwordx4 a[0:3], v5, s[16:19], s8 offen offset:0 sc1
    s_waitcnt vmcnt(9)
    v_mfma_f32_32x32x16_bf16 v[128:143], a[132:135], v[208:211], 0
    v_add_f32 v64, v64, v65
    v_add_f32 v66, v66, v67
    v_mfma_f32_32x32x16_bf16 v[112:127], a[128:131], v[208:211], v[112:127]
    v_add_f32 v68, v68, v69
    s_mov_b32 s63, 0
    s_atomic_umax s63, s[82:83], s72 offset:16388 glc
    s_waitcnt vmcnt(8)
    v_mfma_f32_32x32x16_bf16 v[128:143], a[140:143], v[212:215], v[128:143]
    v_add_f32 v70, v70, v71
    v_add_f32 v64, v64, v66
    v_mfma_f32_32x32x16_bf16 v[112:127], a[136:139], v[212:215], v[112:127]
    v_add_f32 v68, v68, v70
    v_add_f32 v64, v64, v68
    s_waitcnt vmcnt(7)
    v_mfma_f32_32x32x16_bf16 v[128:143], a[148:151], v[216:219], v[128:143]
    v_and_b32 v105, 31, v0
    v_lshl_add_u32 v106, v106, 5, v105
    v_mfma_f32_32x32x16_bf16 v[112:127], a[144:147], v[216:219], v[112:127]
    v_cvt_pk_bf16_f32 v66, v64, v64
    v_and_b32 v66, 0xffff0000, v66
    s_waitcnt vmcnt(6)
    v_mfma_f32_32x32x16_bf16 v[128:143], a[156:159], v[220:223], v[128:143]
    v_sub_f32 v65, v64, v66
    v_cvt_pk_bf16_f32 v65, v66, v65
    v_mfma_f32_32x32x16_bf16 v[112:127], a[152:155], v[220:223], v[112:127]
    s_mov_b32 s42, 161792
    v_lshl_add_u32 v106, v106, 2, s42
    s_waitcnt vmcnt(5)
    v_mfma_f32_32x32x16_bf16 v[128:143], a[164:167], v[224:227], v[128:143]
    v_lshl_add_u32 v105, v105, 2, s42
    ds_write_b32 v106, v65
    v_mfma_f32_32x32x16_bf16 v[112:127], a[160:163], v[224:227], v[112:127]
    v_lshrrev_b32 v24, 1, v0
    v_xor_b32 v24, v24, v0
    s_waitcnt vmcnt(4)
    v_mfma_f32_32x32x16_bf16 v[128:143], a[172:175], v[228:231], v[128:143]
    v_bfe_u32 v24, v24, 2, 1
    v_mul_u32_u24 v24, 12, v24
    v_mfma_f32_32x32x16_bf16 v[112:127], a[168:171], v[228:231], v[112:127]
    v_xor_b32 v24, v24, v0
    v_and_b32 v24, 15, v24
    s_waitcnt vmcnt(3)
    v_mfma_f32_32x32x16_bf16 v[128:143], a[180:183], v[232:235], v[128:143]
    v_lshrrev_b32 v25, 5, v0
    v_lshl_add_u32 v25, v25, 4, v24
    v_mfma_f32_32x32x16_bf16 v[112:127], a[176:179], v[232:235], v[112:127]
    v_lshlrev_b32 v25, 2, v25
    v_add_u32 v105, 161792, v25
    s_waitcnt vmcnt(2)
    v_mfma_f32_32x32x16_bf16 v[128:143], a[188:191], v[236:239], v[128:143]
    v_lshrrev_b32 v25, 4, v0
    v_lshl_add_u32 v24, v25, 5, v24
    v_mfma_f32_32x32x16_bf16 v[112:127], a[184:187], v[236:239], v[112:127]
    v_lshlrev_b32 v24, 4, v24
    v_add_u32 v24, 0x10000, v24
    s_barrier
    s_mov_b32 s57, 0
pl_22:
    s_waitcnt lgkmcnt(0)
    s_cmp_ge_u32 s63, 8
    s_cbranch_scc1 pd_21
    s_atomic_umax s63, s[82:83], s72 offset:16388 glc
    s_add_u32 s57, s57, 1
    s_cmp_lt_u32 s57, 20000
    s_cbranch_scc1 pl_22
    s_waitcnt lgkmcnt(0)
pd_21:
    buffer_load_dwordx4 v[72:75], v1, s[16:19], s73 offen offset:0 sc1
    buffer_load_dwordx4 v[76:79], v1, s[16:19], s73 offen offset:1024 sc1
    buffer_load_dwordx4 v[80:83], v1, s[16:19], s73 offen offset:2048 sc1
    ds_write_b128 v21, v[128:131] offset:40960
    buffer_load_dwordx4 v[84:87], v1, s[16:19], s73 offen offset:3072 sc1
    ds_write_b128 v21, v[132:135] offset:41984
    buffer_load_dwordx4 v[88:91], v4, s[16:19], s73 offen offset:0 sc1
    ds_write_b128 v23, v[136:139] offset:57344
    buffer_load_dwordx4 v[92:95], v4, s[16:19], s73 offen offset:1024 sc1
    ds_write_b128 v23, v[140:143] offset:58368
    buffer_load_dwordx4 v[96:99], v4, s[16:19], s73 offen offset:2048 sc1
    ds_write_b128 v22, v[120:123] offset:49152
    buffer_load_dwordx4 v[100:103], v4, s[16:19], s73 offen offset:3072 sc1
    ds_write_b128 v22, v[124:127] offset:50176
    ds_read_b32 v253, v2
    s_waitcnt lgkmcnt(1)
    s_barrier
    ds_read_b128 v[128:131], v20 offset:40960
    ds_read_b128 v[132:135], v20 offset:41984
    ds_read_b128 v[136:139], v20 offset:49152
    ds_read_b128 v[140:143], v20 offset:50176
    ds_read_b128 v[120:123], v20 offset:57344
    ds_read_b128 v[124:127], v20 offset:58368
    ds_read_b32 v253, v2
    s_waitcnt lgkmcnt(5)
    v_pk_add_f32 v[112:113], v[112:113], v[128:129]
    v_pk_add_f32 v[114:115], v[114:115], v[130:131]
    v_pk_add_f32 v[116:117], v[116:117], v[132:133]
    v_pk_add_f32 v[118:119], v[118:119], v[134:135]
    s_waitcnt lgkmcnt(3)
    v_pk_add_f32 v[112:113], v[112:113], v[136:137]
    v_pk_add_f32 v[114:115], v[114:115], v[138:139]
    v_pk_add_f32 v[116:117], v[116:117], v[140:141]
    v_pk_add_f32 v[118:119], v[118:119], v[142:143]
    s_waitcnt lgkmcnt(1)
    v_pk_add_f32 v[112:113], v[112:113], v[120:121]
    v_pk_add_f32 v[114:115], v[114:115], v[122:123]
    v_pk_add_f32 v[116:117], v[116:117], v[124:125]
    v_pk_add_f32 v[118:119], v[118:119], v[126:127]
    v_cvt_pk_bf16_f32 v8, v112, v113
    v_cvt_pk_bf16_f32 v9, v114, v115
    v_cvt_pk_bf16_f32 v10, v116, v117
    v_cvt_pk_bf16_f32 v11, v118, v119
    buffer_store_dwordx4 v[8:11], v1, s[16:19], s24 offen sc1
    s_barrier
    s_add_u32 s24, s24, 32768
    buffer_load_dwordx4 a[4:7], v5, s[16:19], s12 offen offset:0 sc1
    buffer_load_dwordx4 a[8:11], v5, s[16:19], s9 offen offset:0 sc1
    s_waitcnt vmcnt(10)
    v_mfma_f32_32x32x16_bf16 v[160:175], a[132:135], v[72:75], 0
    buffer_load_dwordx4 a[12:15], v5, s[16:19], s13 offen offset:0 sc1
    v_accvgpr_write_b32 a240, v8
    v_accvgpr_write_b32 a241, v9
    v_mfma_f32_32x32x16_bf16 v[144:159], a[128:131], v[72:75], v[144:159]
    v_accvgpr_write_b32 a242, v10
    buffer_load_dwordx4 a[16:19], v5, s[16:19], s8 offen offset:1024 sc1
    s_waitcnt vmcnt(11)
    v_mfma_f32_32x32x16_bf16 v[160:175], a[140:143], v[76:79], v[160:175]
    v_accvgpr_write_b32 a243, v11
    v_mul_f32 v13, v112, v112
    v_mfma_f32_32x32x16_bf16 v[144:159], a[136:139], v[76:79], v[144:159]
    v_add_f32 v12, v112, v113
    buffer_load_dwordx4 a[20:23], v5, s[16:19], s12 offen offset:1024 sc1
    s_waitcnt vmcnt(11)
    v_mfma_f32_32x32x16_bf16 v[160:175], a[148:151], v[80:83], v[160:175]
    v_fmac_f32 v13, v113, v113
    v_add_f32 v12, v12, v114
    v_fmac_f32 v13, v114, v114
    v_mfma_f32_32x32x16_bf16 v[144:159], a[144:147], v[80:83], v[144:159]
    v_add_f32 v12, v12, v115
    buffer_load_dwordx4 a[24:27], v5, s[16:19], s9 offen offset:1024 sc1
    s_waitcnt vmcnt(11)
    v_mfma_f32_32x32x16_bf16 v[160:175], a[156:159], v[84:87], v[160:175]
    v_fmac_f32 v13, v115, v115
    v_add_f32 v12, v12, v116
    v_mfma_f32_32x32x16_bf16 v[144:159], a[152:155], v[84:87], v[144:159]
    v_fmac_f32 v13, v116, v116
    v_add_f32 v12, v12, v117
    s_waitcnt vmcnt(10)
    v_mfma_f32_32x32x16_bf16 v[160:175], a[164:167], v[88:91], v[160:175]
    buffer_load_dwordx4 a[28:31], v5, s[16:19], s13 offen offset:1024 sc1
    v_fmac_f32 v13, v117, v117
    v_add_f32 v12, v12, v118
    v_mfma_f32_32x32x16_bf16 v[144:159], a[160:163], v[88:91], v[144:159]
    v_fmac_f32 v13, v118, v118
    v_add_f32 v12, v12, v119
    s_waitcnt vmcnt(10)
    v_mfma_f32_32x32x16_bf16 v[160:175], a[172:175], v[92:95], v[160:175]
    v_fmac_f32 v13, v119, v119
    buffer_load_dwordx4 a[32:35], v5, s[16:19], s8 offen offset:2048 sc1
    v_mfma_f32_32x32x16_bf16 v[144:159], a[168:171], v[92:95], v[144:159]
    v_permlane32_swap_b32 v12, v13
    v_add_f32 v12, v12, v13
    s_waitcnt vmcnt(10)
    v_mfma_f32_32x32x16_bf16 v[160:175], a[180:183], v[96:99], v[160:175]
    ds_write_b32 v14, v12 offset:0
    ds_read2_b32 a[224:225], v105 offset0:0 offset1:0
    ds_read2_b32 a[226:227], v105 offset0:32 offset1:32
    v_mfma_f32_32x32x16_bf16 v[144:159], a[176:179], v[96:99], v[144:159]
    buffer_load_dwordx4 a[36:39], v5, s[16:19], s12 offen offset:2048 sc1
    ds_read2_b32 a[228:229], v105 offset0:64 offset1:64
    s_waitcnt vmcnt(10)
    v_mfma_f32_32x32x16_bf16 v[160:175], a[188:191], v[100:103], v[160:175]
    ds_read2_b32 a[230:231], v105 offset0:96 offset1:96
    ds_read2_b32 a[232:233], v105 offset0:128 offset1:128
    v_mfma_f32_32x32x16_bf16 v[144:159], a[184:187], v[100:103], v[144:159]
    ds_read2_b32 a[234:235], v105 offset0:160 offset1:160
    ds_read2_b32 a[236:237], v105 offset0:192 offset1:192
    s_nop 6
    ds_write_b128 v21, v[160:163] offset:40960
    ds_write_b128 v21, v[164:167] offset:41984
    ds_write_b128 v23, v[168:171] offset:57344
    ds_write_b128 v23, v[172:175] offset:58368
    ds_write_b128 v22, v[152:155] offset:49152
    ds_write_b128 v22, v[156:159] offset:50176
    ds_read_b32 v253, v2
    s_waitcnt lgkmcnt(1)
    s_barrier
    ds_read_b128 v[160:163], v20 offset:40960
    ds_read_b128 v[164:167], v20 offset:41984
    ds_read_b128 v[168:171], v20 offset:49152
    ds_read_b128 v[172:175], v20 offset:50176
    ds_read_b128 v[152:155], v20 offset:57344
    ds_read_b128 v[156:159], v20 offset:58368
    ds_read_b32 v253, v2
    s_waitcnt lgkmcnt(5)
    v_pk_add_f32 v[144:145], v[144:145], v[160:161]
    v_pk_add_f32 v[146:147], v[146:147], v[162:163]
    v_pk_add_f32 v[148:149], v[148:149], v[164:165]
    v_pk_add_f32 v[150:151], v[150:151], v[166:167]
    s_waitcnt lgkmcnt(3)
    v_pk_add_f32 v[144:145], v[144:145], v[168:169]
    v_pk_add_f32 v[146:147], v[146:147], v[170:171]
    v_pk_add_f32 v[148:149], v[148:149], v[172:173]
    v_pk_add_f32 v[150:151], v[150:151], v[174:175]
    s_waitcnt lgkmcnt(1)
    v_pk_add_f32 v[144:145], v[144:145], v[152:153]
    v_pk_add_f32 v[146:147], v[146:147], v[154:155]
    v_pk_add_f32 v[148:149], v[148:149], v[156:157]
    v_pk_add_f32 v[150:151], v[150:151], v[158:159]
    v_cvt_pk_bf16_f32 v8, v144, v145
    v_cvt_pk_bf16_f32 v9, v146, v147
    v_cvt_pk_bf16_f32 v10, v148, v149
    v_cvt_pk_bf16_f32 v11, v150, v151
    buffer_store_dwordx4 v[8:11], v1, s[16:19], s24 offen sc1
    v_accvgpr_write_b32 a244, v8
    v_accvgpr_write_b32 a245, v9
    v_accvgpr_write_b32 a246, v10
    v_accvgpr_write_b32 a247, v11
    v_mul_f32 v13, v144, v144
    v_add_f32 v12, v144, v145
    v_fmac_f32 v13, v145, v145
    v_add_f32 v12, v12, v146
    v_fmac_f32 v13, v146, v146
    v_add_f32 v12, v12, v147
    v_fmac_f32 v13, v147, v147
    v_add_f32 v12, v12, v148
    v_fmac_f32 v13, v148, v148
    v_add_f32 v12, v12, v149
    v_fmac_f32 v13, v149, v149
    v_add_f32 v12, v12, v150
    v_fmac_f32 v13, v150, v150
    v_add_f32 v12, v12, v151
    v_fmac_f32 v13, v151, v151
    s_nop 1
    v_permlane32_swap_b32 v12, v13
    v_add_f32 v12, v12, v13
    ds_write_b32 v14, v12 offset:1024
    s_waitcnt vmcnt(10)
    s_barrier
    s_cmp_eq_u32 s32, 0
    s_cbranch_scc0 ow_23
    s_atomic_add s58, s[82:83], s25 offset:32772
ow_23:
    s_add_u32 m0, s61, 131072
    s_add_u32 s85, s91, 131072
    buffer_load_dwordx4 v1, s[16:19], s85 offen offset:0 sc1 lds
    buffer_load_dwordx4 v1, s[16:19], s85 offen offset:1024 sc1 lds
    buffer_load_dwordx4 v1, s[16:19], s85 offen offset:2048 sc1 lds
    buffer_load_dwordx4 v1, s[16:19], s85 offen offset:3072 sc1 lds
    buffer_load_dwordx4 a[40:43], v5, s[16:19], s9 offen offset:2048 sc1
    buffer_load_dwordx4 a[44:47], v5, s[16:19], s13 offen offset:2048 sc1
    buffer_load_dwordx4 a[48:51], v5, s[16:19], s10 offen offset:0 sc1
    buffer_load_dwordx4 a[52:55], v5, s[16:19], s14 offen offset:0 sc1
    buffer_load_dwordx4 a[56:59], v5, s[16:19], s11 offen offset:0 sc1
    buffer_load_dwordx4 a[60:63], v5, s[16:19], s15 offen offset:0 sc1
    ds_read_b32 v253, v2
    s_waitcnt lgkmcnt(1)
    s_waitcnt vmcnt(10)
    s_barrier
    s_cmp_eq_u32 s32, 0
    s_cbranch_scc0 ow_24
    s_atomic_add s58, s[82:83], s25 offset:32900
ow_24:
    s_mov_b32 s64, 0
    s_atomic_umax s64, s[82:83], s26 offset:32772 glc
    s_lshl_b32 s42, s33, 10
    s_add_u32 s42, s42, 159744
    v_lshl_add_u32 v14, v0, 2, s42
    ds_read2st64_b32 v[8:9], v14 offset0:0 offset1:1
    ds_read2st64_b32 v[10:11], v14 offset0:2 offset1:3
    s_lshl_b32 s42, s34, 30
    v_lshl_add_u32 v14, v0, 2, s42
    v_and_b32 v21, 0xffff, v24
    v_add_u32 v25, 0x10000, v24
    ds_read_b128 v[28:31], v21 offset:0
    ds_read_b128 v[32:35], v21 offset:32768
    ds_read_b128 v[36:39], v24 offset:0
    ds_read_b128 v[40:43], v21 offset:256
    ds_read_b128 v[44:47], v21 offset:33024
    ds_read_b128 v[48:51], v24 offset:256
    ds_read_b128 v[52:55], v21 offset:2048
    ds_read_b128 v[56:59], v21 offset:34816
    s_waitcnt lgkmcnt(8)
    v_pk_add_f32 v[8:9], v[8:9], v[10:11]
    v_add_f32 v12, v8, v9
    buffer_store_dword v12, v14, s[16:19], s30 offen sc1
    buffer_load_dwordx4 a[64:67], v5, s[16:19], s10 offen offset:1024 sc1
    buffer_load_dwordx4 a[68:71], v5, s[16:19], s14 offen offset:1024 sc1
    buffer_load_dwordx4 a[72:75], v5, s[16:19], s11 offen offset:1024 sc1
    buffer_load_dwordx4 a[76:79], v5, s[16:19], s15 offen offset:1024 sc1
    buffer_load_dwordx4 a[80:83], v5, s[16:19], s10 offen offset:2048 sc1
    buffer_load_dwordx4 a[84:87], v5, s[16:19], s14 offen offset:2048 sc1
    buffer_load_dwordx4 a[88:91], v5, s[16:19], s11 offen offset:2048 sc1
    buffer_load_dwordx4 a[92:95], v5, s[16:19], s15 offen offset:2048 sc1
    v_mov_b32 v26, v110
    v_mov_b32 v7, v111
    v_and_b32 v9, 0x300, v1
    v_mov_b32 v10, 0
    v_add_u32 v9, v9, v1
    v_add_u32 v11, 4096, v9
    s_add_u32 s73, s27, 8192
    s_add_u32 s74, s27, 16384
    s_add_u32 s75, s27, 24576
    s_mov_b32 s57, 0
pl_26:
    s_waitcnt lgkmcnt(0)
    s_cmp_ge_u32 s64, 8
    s_cbranch_scc1 pd_25
    s_atomic_umax s64, s[82:83], s26 offset:32772 glc
    s_add_u32 s57, s57, 1
    s_cmp_lt_u32 s57, 20000
    s_cbranch_scc1 pl_26
    s_waitcnt lgkmcnt(0)
pd_25:
    buffer_load_dwordx4 v[128:131], v9, s[16:19], s27 offen offset:0 sc1
    buffer_load_dwordx4 v[132:135], v9, s[16:19], s27 offen offset:256 sc1
    buffer_load_dwordx4 v[136:139], v9, s[16:19], s27 offen offset:2048 sc1
    buffer_load_dwordx4 v[140:143], v9, s[16:19], s27 offen offset:2304 sc1
    buffer_load_dwordx4 v[144:147], v11, s[16:19], s27 offen offset:0 sc1
    buffer_load_dwordx4 v[148:151], v11, s[16:19], s27 offen offset:256 sc1
    buffer_load_dwordx4 v[152:155], v11, s[16:19], s27 offen offset:2048 sc1
    buffer_load_dwordx4 v[156:159], v11, s[16:19], s27 offen offset:2304 sc1
    buffer_load_dwordx4 v[160:163], v9, s[16:19], s73 offen offset:0 sc1
    buffer_load_dwordx4 v[164:167], v9, s[16:19], s73 offen offset:256 sc1
    buffer_load_dwordx4 v[168:171], v9, s[16:19], s73 offen offset:2048 sc1
    buffer_load_dwordx4 v[172:175], v9, s[16:19], s73 offen offset:2304 sc1
    s_waitcnt vmcnt(20)
    s_lshl_b32 s42, s33, 7
    s_add_u32 s42, s42, s25
    s_cmp_eq_u32 s34, 0
    s_cbranch_scc0 ow_27
    s_atomic_add s58, s[82:83], s42 offset:40964
ow_27:
    s_waitcnt vmcnt(10)
    v_mfma_f32_16x16x32_bf16 v[64:67], v[28:31], v[128:131], 0
    ds_read_b128 v[60:63], v24 offset:2048
    v_mfma_f32_16x16x32_bf16 v[68:71], v[28:31], v[132:135], 0
    buffer_load_dwordx4 v[176:179], v11, s[16:19], s73 offen offset:0 sc1
    v_mfma_f32_16x16x32_bf16 v[80:83], v[32:35], v[128:131], 0
    ds_read_b128 v[28:31], v21 offset:2304
    v_mfma_f32_16x16x32_bf16 v[84:87], v[32:35], v[132:135], 0
    v_mfma_f32_16x16x32_bf16 v[96:99], v[36:39], v[128:131], 0
    ds_read_b128 v[32:35], v21 offset:35072
    v_mfma_f32_16x16x32_bf16 v[100:103], v[36:39], v[132:135], 0
    buffer_load_dwordx4 v[180:183], v11, s[16:19], s73 offen offset:256 sc1
    v_mfma_f32_16x16x32_bf16 v[72:75], v[40:43], v[128:131], 0
    ds_read_b128 v[36:39], v24 offset:2304
    v_mfma_f32_16x16x32_bf16 v[76:79], v[40:43], v[132:135], 0
    v_mfma_f32_16x16x32_bf16 v[88:91], v[44:47], v[128:131], 0
    ds_read_b128 v[40:43], v21 offset:4096
    v_mfma_f32_16x16x32_bf16 v[92:95], v[44:47], v[132:135], 0
    buffer_load_dwordx4 v[184:187], v11, s[16:19], s73 offen offset:2048 sc1
    v_mfma_f32_16x16x32_bf16 v[104:107], v[48:51], v[128:131], 0
    ds_read_b128 v[44:47], v21 offset:36864
    v_mfma_f32_16x16x32_bf16 v[108:111], v[48:51], v[132:135], 0
    s_waitcnt vmcnt(11)
    s_waitcnt lgkmcnt(5)
    v_mfma_f32_16x16x32_bf16 v[64:67], v[52:55], v[136:139], v[64:67]
    ds_read_b128 v[48:51], v24 offset:4096
    v_mfma_f32_16x16x32_bf16 v[68:71], v[52:55], v[140:143], v[68:71]
    buffer_load_dwordx4 v[188:191], v11, s[16:19], s73 offen offset:2304 sc1
    v_mfma_f32_16x16x32_bf16 v[80:83], v[56:59], v[136:139], v[80:83]
    ds_read_b128 v[52:55], v21 offset:4352
    v_mfma_f32_16x16x32_bf16 v[84:87], v[56:59], v[140:143], v[84:87]
    v_mfma_f32_16x16x32_bf16 v[96:99], v[60:63], v[136:139], v[96:99]
    ds_read_b128 v[56:59], v21 offset:37120
    v_mfma_f32_16x16x32_bf16 v[100:103], v[60:63], v[140:143], v[100:103]
    buffer_load_dwordx4 v[192:195], v9, s[16:19], s74 offen offset:0 sc1
    s_waitcnt lgkmcnt(5)
    v_mfma_f32_16x16x32_bf16 v[72:75], v[28:31], v[136:139], v[72:75]
    ds_read_b128 v[60:63], v24 offset:4352
    v_mfma_f32_16x16x32_bf16 v[76:79], v[28:31], v[140:143], v[76:79]
    v_mfma_f32_16x16x32_bf16 v[88:91], v[32:35], v[136:139], v[88:91]
    ds_read_b128 v[28:31], v21 offset:6144
    v_mfma_f32_16x16x32_bf16 v[92:95], v[32:35], v[140:143], v[92:95]
    buffer_load_dwordx4 v[196:199], v9, s[16:19], s74 offen offset:256 sc1
    v_mfma_f32_16x16x32_bf16 v[104:107], v[36:39], v[136:139], v[104:107]
    ds_read_b128 v[32:35], v21 offset:38912
    v_mfma_f32_16x16x32_bf16 v[108:111], v[36:39], v[140:143], v[108:111]
    s_waitcnt vmcnt(12)
    s_waitcnt lgkmcnt(5)
    v_mfma_f32_16x16x32_bf16 v[64:67], v[40:43], v[144:147], v[64:67]
    ds_read_b128 v[36:39], v24 offset:6144
    v_mfma_f32_16x16x32_bf16 v[68:71], v[40:43], v[148:151], v[68:71]
    buffer_load_dwordx4 v[200:203], v9, s[16:19], s74 offen offset:2048 sc1
    v_mfma_f32_16x16x32_bf16 v[80:83], v[44:47], v[144:147], v[80:83]
    ds_read_b128 v[40:43], v21 offset:6400
    v_mfma_f32_16x16x32_bf16 v[84:87], v[44:47], v[148:151], v[84:87]
    v_mfma_f32_16x16x32_bf16 v[96:99], v[48:51], v[144:147], v[96:99]
    ds_read_b128 v[44:47], v21 offset:39168
    v_mfma_f32_16x16x32_bf16 v[100:103], v[48:51], v[148:151], v[100:103]
    buffer_load_dwordx4 v[204:207], v9, s[16:19], s74 offen offset:2304 sc1
    s_waitcnt lgkmcnt(5)
    v_mfma_f32_16x16x32_bf16 v[72:75], v[52:55], v[144:147], v[72:75]
    ds_read_b128 v[48:51], v24 offset:6400
    v_mfma_f32_16x16x32_bf16 v[76:79], v[52:55], v[148:151], v[76:79]
    v_mfma_f32_16x16x32_bf16 v[88:91], v[56:59], v[144:147], v[88:91]
    ds_read_b128 v[52:55], v21 offset:8192
    v_mfma_f32_16x16x32_bf16 v[92:95], v[56:59], v[148:151], v[92:95]
    buffer_load_dwordx4 v[208:211], v11, s[16:19], s74 offen offset:0 sc1
    v_mfma_f32_16x16x32_bf16 v[104:107], v[60:63], v[144:147], v[104:107]
    ds_read_b128 v[56:59], v21 offset:40960
    v_mfma_f32_16x16x32_bf16 v[108:111], v[60:63], v[148:151], v[108:111]
    s_waitcnt vmcnt(13)
    s_waitcnt lgkmcnt(5)
    v_mfma_f32_16x16x32_bf16 v[64:67], v[28:31], v[152:155], v[64:67]
    ds_read_b128 v[60:63], v24 offset:8192
    v_mfma_f32_16x16x32_bf16 v[68:71], v[28:31], v[156:159], v[68:71]
    buffer_load_dwordx4 v[212:215], v11, s[16:19], s74 offen offset:256 sc1
    v_mfma_f32_16x16x32_bf16 v[80:83], v[32:35], v[152:155], v[80:83]
    ds_read_b128 v[28:31], v21 offset:8448
    v_mfma_f32_16x16x32_bf16 v[84:87], v[32:35], v[156:159], v[84:87]
    v_mfma_f32_16x16x32_bf16 v[96:99], v[36:39], v[152:155], v[96:99]
    ds_read_b128 v[32:35], v21 offset:41216
    v_mfma_f32_16x16x32_bf16 v[100:103], v[36:39], v[156:159], v[100:103]
    buffer_load_dwordx4 v[216:219], v11, s[16:19], s74 offen offset:2048 sc1
    s_waitcnt lgkmcnt(5)
    v_mfma_f32_16x16x32_bf16 v[72:75], v[40:43], v[152:155], v[72:75]
    ds_read_b128 v[36:39], v24 offset:8448
    v_mfma_f32_16x16x32_bf16 v[76:79], v[40:43], v[156:159], v[76:79]
    v_mfma_f32_16x16x32_bf16 v[88:91], v[44:47], v[152:155], v[88:91]
    ds_read_b128 v[40:43], v21 offset:10240
    v_mfma_f32_16x16x32_bf16 v[92:95], v[44:47], v[156:159], v[92:95]
    buffer_load_dwordx4 v[220:223], v11, s[16:19], s74 offen offset:2304 sc1
    v_mfma_f32_16x16x32_bf16 v[104:107], v[48:51], v[152:155], v[104:107]
    ds_read_b128 v[44:47], v21 offset:43008
    v_mfma_f32_16x16x32_bf16 v[108:111], v[48:51], v[156:159], v[108:111]
    s_waitcnt vmcnt(14)
    s_waitcnt lgkmcnt(5)
    v_mfma_f32_16x16x32_bf16 v[64:67], v[52:55], v[160:163], v[64:67]
    ds_read_b128 v[48:51], v24 offset:10240
    v_mfma_f32_16x16x32_bf16 v[68:71], v[52:55], v[164:167], v[68:71]
    buffer_load_dwordx4 v[224:227], v9, s[16:19], s75 offen offset:0 sc1
    s_mov_b64 exec, 32
    buffer_load_dword v27, v26, s[16:19], 0 offen sc1
    s_mov_b64 exec, -1
    v_mfma_f32_16x16x32_bf16 v[80:83], v[56:59], v[160:163], v[80:83]
    ds_read_b128 v[52:55], v21 offset:10496
    v_mfma_f32_16x16x32_bf16 v[84:87], v[56:59], v[164:167], v[84:87]
    v_mfma_f32_16x16x32_bf16 v[96:99], v[60:63], v[160:163], v[96:99]
    ds_read_b128 v[56:59], v21 offset:43264
    v_mfma_f32_16x16x32_bf16 v[100:103], v[60:63], v[164:167], v[100:103]
    buffer_load_dwordx4 v[228:231], v9, s[16:19], s75 offen offset:256 sc1
    s_waitcnt lgkmcnt(5)
    v_mfma_f32_16x16x32_bf16 v[72:75], v[28:31], v[160:163], v[72:75]
    ds_read_b128 v[60:63], v24 offset:10496
    v_mfma_f32_16x16x32_bf16 v[76:79], v[28:31], v[164:167], v[76:79]
    v_mfma_f32_16x16x32_bf16 v[88:91], v[32:35], v[160:163], v[88:91]
    ds_read_b128 v[28:31], v21 offset:12288
    v_mfma_f32_16x16x32_bf16 v[92:95], v[32:35], v[164:167], v[92:95]
    buffer_load_dwordx4 v[232:235], v9, s[16:19], s75 offen offset:2048 sc1
    v_mfma_f32_16x16x32_bf16 v[104:107], v[36:39], v[160:163], v[104:107]
    ds_read_b128 v[32:35], v21 offset:45056
    v_mfma_f32_16x16x32_bf16 v[108:111], v[36:39], v[164:167], v[108:111]
    s_waitcnt vmcnt(16)
    s_waitcnt lgkmcnt(5)
    v_mfma_f32_16x16x32_bf16 v[64:67], v[40:43], v[168:171], v[64:67]
    ds_read_b128 v[36:39], v24 offset:12288
    v_mfma_f32_16x16x32_bf16 v[68:71], v[40:43], v[172:175], v[68:71]
    buffer_load_dwordx4 v[236:239], v9, s[16:19], s75 offen offset:2304 sc1
    v_mfma_f32_16x16x32_bf16 v[80:83], v[44:47], v[168:171], v[80:83]
    ds_read_b128 v[40:43], v21 offset:12544
    v_mfma_f32_16x16x32_bf16 v[84:87], v[44:47], v[172:175], v[84:87]
    v_mfma_f32_16x16x32_bf16 v[96:99], v[48:51], v[168:171], v[96:99]
    ds_read_b128 v[44:47], v21 offset:45312
    v_mfma_f32_16x16x32_bf16 v[100:103], v[48:51], v[172:175], v[100:103]
    buffer_load_dwordx4 v[240:243], v11, s[16:19], s75 offen offset:0 sc1
    s_waitcnt lgkmcnt(5)
    v_mfma_f32_16x16x32_bf16 v[72:75], v[52:55], v[168:171], v[72:75]
    ds_read_b128 v[48:51], v24 offset:12544
    v_mfma_f32_16x16x32_bf16 v[76:79], v[52:55], v[172:175], v[76:79]
    v_mfma_f32_16x16x32_bf16 v[88:91], v[56:59], v[168:171], v[88:91]
    ds_read_b128 v[52:55], v21 offset:14336
    v_mfma_f32_16x16x32_bf16 v[92:95], v[56:59], v[172:175], v[92:95]
    buffer_load_dwordx4 v[244:247], v11, s[16:19], s75 offen offset:256 sc1
    v_mfma_f32_16x16x32_bf16 v[104:107], v[60:63], v[168:171], v[104:107]
    ds_read_b128 v[56:59], v21 offset:47104
    v_mfma_f32_16x16x32_bf16 v[108:111], v[60:63], v[172:175], v[108:111]
    s_waitcnt vmcnt(17)
    s_waitcnt lgkmcnt(5)
    v_mfma_f32_16x16x32_bf16 v[64:67], v[28:31], v[176:179], v[64:67]
    ds_read_b128 v[60:63], v24 offset:14336
    v_mfma_f32_16x16x32_bf16 v[68:71], v[28:31], v[180:183], v[68:71]
    buffer_load_dwordx4 v[248:251], v11, s[16:19], s75 offen offset:2048 sc1
    v_mfma_f32_16x16x32_bf16 v[80:83], v[32:35], v[176:179], v[80:83]
    ds_read_b128 v[28:31], v21 offset:14592
    v_mfma_f32_16x16x32_bf16 v[84:87], v[32:35], v[180:183], v[84:87]
    v_mfma_f32_16x16x32_bf16 v[96:99], v[36:39], v[176:179], v[96:99]
    ds_read_b128 v[32:35], v21 offset:47360
    v_mfma_f32_16x16x32_bf16 v[100:103], v[36:39], v[180:183], v[100:103]
    buffer_load_dwordx4 v[252:255], v11, s[16:19], s75 offen offset:2304 sc1
    s_waitcnt lgkmcnt(5)
    v_mfma_f32_16x16x32_bf16 v[72:75], v[40:43], v[176:179], v[72:75]
    ds_read_b128 v[36:39], v24 offset:14592
    v_mfma_f32_16x16x32_bf16 v[76:79], v[40:43], v[180:183], v[76:79]
    v_mfma_f32_16x16x32_bf16 v[88:91], v[44:47], v[176:179], v[88:91]
    ds_read_b128 v[40:43], v21 offset:16384
    v_mfma_f32_16x16x32_bf16 v[92:95], v[44:47], v[180:183], v[92:95]
    v_mfma_f32_16x16x32_bf16 v[104:107], v[48:51], v[176:179], v[104:107]
    ds_read_b128 v[44:47], v21 offset:49152
    v_mfma_f32_16x16x32_bf16 v[108:111], v[48:51], v[180:183], v[108:111]
    s_waitcnt vmcnt(17)
    s_waitcnt lgkmcnt(5)
    v_mfma_f32_16x16x32_bf16 v[64:67], v[52:55], v[184:187], v[64:67]
    ds_read_b128 v[48:51], v24 offset:16384
    v_mfma_f32_16x16x32_bf16 v[68:71], v[52:55], v[188:191], v[68:71]
    v_mfma_f32_16x16x32_bf16 v[80:83], v[56:59], v[184:187], v[80:83]
    ds_read_b128 v[52:55], v21 offset:16640
    v_mfma_f32_16x16x32_bf16 v[84:87], v[56:59], v[188:191], v[84:87]
    v_mfma_f32_16x16x32_bf16 v[96:99], v[60:63], v[184:187], v[96:99]
    ds_read_b128 v[56:59], v21 offset:49408
    v_mfma_f32_16x16x32_bf16 v[100:103], v[60:63], v[188:191], v[100:103]
    s_waitcnt lgkmcnt(5)
    v_mfma_f32_16x16x32_bf16 v[72:75], v[28:31], v[184:187], v[72:75]
    ds_read_b128 v[60:63], v24 offset:16640
    v_mfma_f32_16x16x32_bf16 v[76:79], v[28:31], v[188:191], v[76:79]
    buffer_load_dwordx4 a[96:99], v5, s[16:19], s8 offen offset:3072 sc1
    v_mfma_f32_16x16x32_bf16 v[88:91], v[32:35], v[184:187], v[88:91]
    ds_read_b128 v[28:31], v21 offset:18432
    v_mfma_f32_16x16x32_bf16 v[92:95], v[32:35], v[188:191], v[92:95]
    s_waitcnt vmcnt(8)
    v_cmp_lt_u32 vcc, v27, v7
    s_and_b32 s57, vcc_lo, 32
    s_cbranch_scc1 gs_28
gb_29:
    v_lshlrev_b32 v27, 2, v0
    buffer_load_dword v12, v27, s[16:19], s31 offen offset:0 sc1
    v_mfma_f32_16x16x32_bf16 v[104:107], v[36:39], v[184:187], v[104:107]
    ds_read_b128 v[32:35], v21 offset:51200
    v_mfma_f32_16x16x32_bf16 v[108:111], v[36:39], v[188:191], v[108:111]
    s_barrier
    s_waitcnt lgkmcnt(5)
    v_mfma_f32_16x16x32_bf16 v[64:67], v[40:43], v[192:195], v[64:67]
    ds_read_b128 v[36:39], v24 offset:18432
    v_mfma_f32_16x16x32_bf16 v[68:71], v[40:43], v[196:199], v[68:71]
    s_add_u32 m0, s61, 0
    s_add_u32 s85, s91, 147456
    buffer_load_dwordx4 v1, s[16:19], s85 offen offset:0 sc1 lds
    v_mfma_f32_16x16x32_bf16 v[80:83], v[44:47], v[192:195], v[80:83]
    ds_read_b128 v[40:43], v21 offset:18688
    v_mfma_f32_16x16x32_bf16 v[84:87], v[44:47], v[196:199], v[84:87]
    buffer_load_dword v13, v27, s[16:19], s31 offen offset:256 sc1
    v_mfma_f32_16x16x32_bf16 v[96:99], v[48:51], v[192:195], v[96:99]
    ds_read_b128 v[44:47], v21 offset:51456
    buffer_load_dwordx4 v1, s[16:19], s85 offen offset:1024 sc1 lds
    v_mfma_f32_16x16x32_bf16 v[100:103], v[48:51], v[196:199], v[100:103]
    s_waitcnt lgkmcnt(5)
    v_mfma_f32_16x16x32_bf16 v[72:75], v[52:55], v[192:195], v[72:75]
    ds_read_b128 v[48:51], v24 offset:18688
    v_mfma_f32_16x16x32_bf16 v[76:79], v[52:55], v[196:199], v[76:79]
    v_mfma_f32_16x16x32_bf16 v[88:91], v[56:59], v[192:195], v[88:91]
    ds_read_b128 v[52:55], v21 offset:20480
    v_mfma_f32_16x16x32_bf16 v[92:95], v[56:59], v[196:199], v[92:95]
    buffer_load_dword v14, v27, s[16:19], s31 offen offset:512 sc1
    v_mfma_f32_16x16x32_bf16 v[104:107], v[60:63], v[192:195], v[104:107]
    ds_read_b128 v[56:59], v21 offset:53248
    buffer_load_dwordx4 v1, s[16:19], s85 offen offset:2048 sc1 lds
    v_mfma_f32_16x16x32_bf16 v[108:111], v[60:63], v[196:199], v[108:111]
    s_waitcnt lgkmcnt(5)
    v_mfma_f32_16x16x32_bf16 v[64:67], v[28:31], v[200:203], v[64:67]
    ds_read_b128 v[60:63], v24 offset:20480
    v_mfma_f32_16x16x32_bf16 v[68:71], v[28:31], v[204:207], v[68:71]
    v_mfma_f32_16x16x32_bf16 v[80:83], v[32:35], v[200:203], v[80:83]
    ds_read_b128 v[28:31], v21 offset:20736
    v_mfma_f32_16x16x32_bf16 v[84:87], v[32:35], v[204:207], v[84:87]
    buffer_load_dword v15, v27, s[16:19], s31 offen offset:768 sc1
    v_mfma_f32_16x16x32_bf16 v[96:99], v[36:39], v[200:203], v[96:99]
    ds_read_b128 v[32:35], v21 offset:53504
    buffer_load_dwordx4 v1, s[16:19], s85 offen offset:3072 sc1 lds
    v_mfma_f32_16x16x32_bf16 v[100:103], v[36:39], v[204:207], v[100:103]
    s_waitcnt lgkmcnt(5)
    v_mfma_f32_16x16x32_bf16 v[72:75], v[40:43], v[200:203], v[72:75]
    ds_read_b128 v[36:39], v24 offset:20736
    v_mfma_f32_16x16x32_bf16 v[76:79], v[40:43], v[204:207], v[76:79]
    v_mfma_f32_16x16x32_bf16 v[88:91], v[44:47], v[200:203], v[88:91]
    ds_read_b128 v[40:43], v21 offset:22528
    v_mfma_f32_16x16x32_bf16 v[92:95], v[44:47], v[204:207], v[92:95]
    buffer_load_dword v16, v27, s[16:19], s31 offen offset:1024 sc1
    v_mfma_f32_16x16x32_bf16 v[104:107], v[48:51], v[200:203], v[104:107]
    ds_read_b128 v[44:47], v21 offset:55296
    s_add_u32 m0, s61, 32768
    s_add_u32 s85, s91, 180224
    buffer_load_dwordx4 v1, s[16:19], s85 offen offset:0 sc1 lds
    v_mfma_f32_16x16x32_bf16 v[108:111], v[48:51], v[204:207], v[108:111]
    s_waitcnt lgkmcnt(5)
    v_mfma_f32_16x16x32_bf16 v[64:67], v[52:55], v[208:211], v[64:67]
    ds_read_b128 v[48:51], v24 offset:22528
    v_mfma_f32_16x16x32_bf16 v[68:71], v[52:55], v[212:215], v[68:71]
    v_mfma_f32_16x16x32_bf16 v[80:83], v[56:59], v[208:211], v[80:83]
    ds_read_b128 v[52:55], v21 offset:22784
    v_mfma_f32_16x16x32_bf16 v[84:87], v[56:59], v[212:215], v[84:87]
    buffer_load_dword v17, v27, s[16:19], s31 offen offset:1280 sc1
    v_mfma_f32_16x16x32_bf16 v[96:99], v[60:63], v[208:211], v[96:99]
    ds_read_b128 v[56:59], v21 offset:55552
    buffer_load_dwordx4 v1, s[16:19], s85 offen offset:1024 sc1 lds
    v_mfma_f32_16x16x32_bf16 v[100:103], v[60:63], v[212:215], v[100:103]
    s_waitcnt lgkmcnt(5)
    v_mfma_f32_16x16x32_bf16 v[72:75], v[28:31], v[208:211], v[72:75]
    ds_read_b128 v[60:63], v24 offset:22784
    v_mfma_f32_16x16x32_bf16 v[76:79], v[28:31], v[212:215], v[76:79]
    v_mfma_f32_16x16x32_bf16 v[88:91], v[32:35], v[208:211], v[88:91]
    ds_read_b128 v[28:31], v21 offset:24576
    v_mfma_f32_16x16x32_bf16 v[92:95], v[32:35], v[212:215], v[92:95]
    buffer_load_dwordx4 v1, s[16:19], s85 offen offset:2048 sc1 lds
    buffer_load_dword v18, v27, s[16:19], s31 offen offset:1536 sc1
    v_mfma_f32_16x16x32_bf16 v[104:107], v[36:39], v[208:211], v[104:107]
    ds_read_b128 v[32:35], v21 offset:57344
    v_mfma_f32_16x16x32_bf16 v[108:111], v[36:39], v[212:215], v[108:111]
    s_waitcnt lgkmcnt(5)
    v_mfma_f32_16x16x32_bf16 v[64:67], v[40:43], v[216:219], v[64:67]
    ds_read_b128 v[36:39], v24 offset:24576
    v_mfma_f32_16x16x32_bf16 v[68:71], v[40:43], v[220:223], v[68:71]
    v_mfma_f32_16x16x32_bf16 v[80:83], v[44:47], v[216:219], v[80:83]
    ds_read_b128 v[40:43], v21 offset:24832
    v_mfma_f32_16x16x32_bf16 v[84:87], v[44:47], v[220:223], v[84:87]
    buffer_load_dwordx4 v1, s[16:19], s85 offen offset:3072 sc1 lds
    buffer_load_dword v19, v27, s[16:19], s31 offen offset:1792 sc1
    v_mfma_f32_16x16x32_bf16 v[96:99], v[48:51], v[216:219], v[96:99]
    ds_read_b128 v[44:47], v21 offset:57600
    v_mfma_f32_16x16x32_bf16 v[100:103], v[48:51], v[220:223], v[100:103]
    s_waitcnt lgkmcnt(5)
    v_mfma_f32_16x16x32_bf16 v[72:75], v[52:55], v[216:219], v[72:75]
    ds_read_b128 v[48:51], v24 offset:24832
    v_mfma_f32_16x16x32_bf16 v[76:79], v[52:55], v[220:223], v[76:79]
    v_mfma_f32_16x16x32_bf16 v[88:91], v[56:59], v[216:219], v[88:91]
    ds_read_b128 v[52:55], v21 offset:26624
    v_mfma_f32_16x16x32_bf16 v[92:95], v[56:59], v[220:223], v[92:95]
    s_add_u32 m0, s61, 65536
    s_add_u32 s85, s91, 212992
    buffer_load_dwordx4 v1, s[16:19], s85 offen offset:0 sc1 lds
    v_mfma_f32_16x16x32_bf16 v[104:107], v[60:63], v[216:219], v[104:107]
    ds_read_b128 v[56:59], v21 offset:59392
    v_mfma_f32_16x16x32_bf16 v[108:111], v[60:63], v[220:223], v[108:111]
    s_waitcnt vmcnt(24)
    s_waitcnt lgkmcnt(5)
    v_mfma_f32_16x16x32_bf16 v[64:67], v[28:31], v[224:227], v[64:67]
    ds_read_b128 v[60:63], v24 offset:26624
    v_mfma_f32_16x16x32_bf16 v[68:71], v[28:31], v[228:231], v[68:71]
    v_mfma_f32_16x16x32_bf16 v[80:83], v[32:35], v[224:227], v[80:83]
    ds_read_b128 v[28:31], v21 offset:26880
    v_mfma_f32_16x16x32_bf16 v[84:87], v[32:35], v[228:231], v[84:87]
    buffer_load_dwordx4 v1, s[16:19], s85 offen offset:1024 sc1 lds
    v_mfma_f32_16x16x32_bf16 v[96:99], v[36:39], v[224:227], v[96:99]
    ds_read_b128 v[32:35], v21 offset:59648
    v_mfma_f32_16x16x32_bf16 v[100:103], v[36:39], v[228:231], v[100:103]
    s_waitcnt lgkmcnt(5)
    v_mfma_f32_16x16x32_bf16 v[72:75], v[40:43], v[224:227], v[72:75]
    ds_read_b128 v[36:39], v24 offset:26880
    v_mfma_f32_16x16x32_bf16 v[76:79], v[40:43], v[228:231], v[76:79]
    buffer_load_dwordx4 v1, s[16:19], s85 offen offset:2048 sc1 lds
    v_mfma_f32_16x16x32_bf16 v[88:91], v[44:47], v[224:227], v[88:91]
    ds_read_b128 v[40:43], v21 offset:28672
    v_mfma_f32_16x16x32_bf16 v[92:95], v[44:47], v[228:231], v[92:95]
    v_mfma_f32_16x16x32_bf16 v[104:107], v[48:51], v[224:227], v[104:107]
    ds_read_b128 v[44:47], v21 offset:61440
    v_mfma_f32_16x16x32_bf16 v[108:111], v[48:51], v[228:231], v[108:111]
    s_waitcnt vmcnt(24)
    s_waitcnt lgkmcnt(5)
    v_mfma_f32_16x16x32_bf16 v[64:67], v[52:55], v[232:235], v[64:67]
    ds_read_b128 v[48:51], v24 offset:28672
    v_mfma_f32_16x16x32_bf16 v[68:71], v[52:55], v[236:239], v[68:71]
    buffer_load_dwordx4 v1, s[16:19], s85 offen offset:3072 sc1 lds
    v_mfma_f32_16x16x32_bf16 v[80:83], v[56:59], v[232:235], v[80:83]
    ds_read_b128 v[52:55], v21 offset:28928
    v_mfma_f32_16x16x32_bf16 v[84:87], v[56:59], v[236:239], v[84:87]
    v_mfma_f32_16x16x32_bf16 v[96:99], v[60:63], v[232:235], v[96:99]
    ds_read_b128 v[56:59], v21 offset:61696
    v_mfma_f32_16x16x32_bf16 v[100:103], v[60:63], v[236:239], v[100:103]
    s_waitcnt lgkmcnt(5)
    v_mfma_f32_16x16x32_bf16 v[72:75], v[28:31], v[232:235], v[72:75]
    ds_read_b128 v[60:63], v24 offset:28928
    v_mfma_f32_16x16x32_bf16 v[76:79], v[28:31], v[236:239], v[76:79]
    buffer_load_dwordx4 a[100:103], v5, s[16:19], s12 offen offset:3072 sc1
    v_mfma_f32_16x16x32_bf16 v[88:91], v[32:35], v[232:235], v[88:91]
    ds_read_b128 v[28:31], v21 offset:30720
    v_mfma_f32_16x16x32_bf16 v[92:95], v[32:35], v[236:239], v[92:95]
    v_mfma_f32_16x16x32_bf16 v[104:107], v[36:39], v[232:235], v[104:107]
    ds_read_b128 v[32:35], v21 offset:63488
    v_mfma_f32_16x16x32_bf16 v[108:111], v[36:39], v[236:239], v[108:111]
    s_waitcnt vmcnt(24)
    s_waitcnt lgkmcnt(5)
    v_mfma_f32_16x16x32_bf16 v[64:67], v[40:43], v[240:243], v[64:67]
    ds_read_b128 v[36:39], v24 offset:30720
    v_mfma_f32_16x16x32_bf16 v[68:71], v[40:43], v[244:247], v[68:71]
    buffer_load_dwordx4 a[104:107], v5, s[16:19], s9 offen offset:3072 sc1
    s_waitcnt vmcnt(6)
    v_mfma_f32_16x16x32_bf16 v[80:83], v[44:47], v[240:243], v[80:83]
    ds_read_b128 v[40:43], v21 offset:30976
    v_add_f32 v12, v12, v13
    v_mfma_f32_16x16x32_bf16 v[84:87], v[44:47], v[244:247], v[84:87]
    v_add_f32 v14, v14, v15
    v_add_f32 v16, v16, v17
    v_mfma_f32_16x16x32_bf16 v[96:99], v[48:51], v[240:243], v[96:99]
    ds_read_b128 v[44:47], v21 offset:63744
    v_add_f32 v18, v18, v19
    v_mfma_f32_16x16x32_bf16 v[100:103], v[48:51], v[244:247], v[100:103]
    v_add_f32 v12, v12, v14
    s_waitcnt lgkmcnt(5)
    v_mfma_f32_16x16x32_bf16 v[72:75], v[52:55], v[240:243], v[72:75]
    ds_read_b128 v[48:51], v24 offset:30976
    v_add_f32 v16, v16, v18
    v_mfma_f32_16x16x32_bf16 v[76:79], v[52:55], v[244:247], v[76:79]
    buffer_load_dwordx4 a[108:111], v5, s[16:19], s13 offen offset:3072 sc1
    v_add_f32 v12, v12, v16
    v_mfma_f32_16x16x32_bf16 v[88:91], v[56:59], v[240:243], v[88:91]
    ds_read_b128 v[52:55], v24 offset:32768
    v_mul_f32 v12, 0x3b000000, v12
    v_mfma_f32_16x16x32_bf16 v[92:95], v[56:59], v[244:247], v[92:95]
    v_mov_b32 v13, v12
    v_mfma_f32_16x16x32_bf16 v[104:107], v[60:63], v[240:243], v[104:107]
    ds_read_b128 v[56:59], v24 offset:33024
    buffer_load_dwordx4 a[112:115], v6, s[16:19], s8 offen offset:0 sc1
    v_mfma_f32_16x16x32_bf16 v[108:111], v[60:63], v[244:247], v[108:111]
    v_permlane32_swap_b32 v12, v13
    s_waitcnt lgkmcnt(5)
    v_mfma_f32_16x16x32_bf16 v[64:67], v[28:31], v[248:251], v[64:67]
    ds_read_b128 v[60:63], v24 offset:34816
    v_fma_f32 v13, -v12, v12, v13
    v_mfma_f32_16x16x32_bf16 v[68:71], v[28:31], v[252:255], v[68:71]
    v_max_f32 v13, 0, v13
    v_add_f32 v13, 0x3727c5ac, v13
    v_mfma_f32_16x16x32_bf16 v[80:83], v[32:35], v[248:251], v[80:83]
    ds_read_b128 v[28:31], v24 offset:35072
    v_rcp_f32 v2, v13
    v_mfma_f32_16x16x32_bf16 v[84:87], v[32:35], v[252:255], v[84:87]
    v_cvt_pk_bf16_f32 v8, -v12, -v12
    v_and_b32 v9, 0xffff0000, v8
    v_mfma_f32_16x16x32_bf16 v[96:99], v[36:39], v[248:251], v[96:99]
    ds_read_b128 v[32:35], v24 offset:36864
    buffer_load_dwordx4 a[116:119], v6, s[16:19], s12 offen offset:0 sc1
    v_mfma_f32_16x16x32_bf16 v[100:103], v[36:39], v[252:255], v[100:103]
    v_sub_f32 v9, -v12, v9
    s_waitcnt lgkmcnt(5)
    v_mfma_f32_16x16x32_bf16 v[72:75], v[40:43], v[248:251], v[72:75]
    ds_read_b128 v[36:39], v24 offset:37120
    v_cvt_pk_bf16_f32 v9, v9, v9
    v_mfma_f32_16x16x32_bf16 v[76:79], v[40:43], v[252:255], v[76:79]
    s_lshl_b32 s42, s40, 8
    s_lshl1_add_u32 s31, s31, s42
    v_mfma_f32_16x16x32_bf16 v[88:91], v[44:47], v[248:251], v[88:91]
    ds_read_b128 v[40:43], v24 offset:38912
    s_sub_u32 s31, s31, 9175040
    v_mfma_f32_16x16x32_bf16 v[92:95], v[44:47], v[252:255], v[92:95]
    buffer_store_dword v2, v27, s[16:19], s31 offen sc1
    v_mfma_f32_16x16x32_bf16 v[104:107], v[48:51], v[248:251], v[104:107]
    ds_read_b128 v[44:47], v24 offset:39168
    buffer_load_dwordx4 a[120:123], v6, s[16:19], s9 offen offset:0 sc1
    v_mfma_f32_16x16x32_bf16 v[108:111], v[48:51], v[252:255], v[108:111]
    v_mfma_f32_16x16x4_4b_bf16 v[64:79], a[224:225], v[8:9], v[64:79]
    s_barrier
    s_waitcnt lgkmcnt(5)
    v_mfma_f32_16x16x32_bf16 v[112:115], v[52:55], v[128:131], 0
    ds_read_b128 v[48:51], v24 offset:40960
    v_mfma_f32_16x16x32_bf16 v[116:119], v[52:55], v[132:135], 0
    v_mfma_f32_16x16x4_4b_bf16 v[80:95], a[226:227], v[8:9], v[80:95]
    v_mfma_f32_16x16x32_bf16 v[120:123], v[56:59], v[128:131], 0
    ds_read_b128 v[52:55], v24 offset:41216
    v_mfma_f32_16x16x32_bf16 v[124:127], v[56:59], v[132:135], 0
    v_mfma_f32_16x16x4_4b_bf16 v[96:111], a[228:229], v[8:9], v[96:111]
    v_mfma_f32_16x16x32_bf16 v[112:115], v[60:63], v[136:139], v[112:115]
    ds_read_b128 v[56:59], v24 offset:43008
    s_add_u32 m0, s61, 16384
    s_add_u32 s85, s91, 163840
    buffer_load_dwordx4 v1, s[16:19], s85 offen offset:0 sc1 lds
    v_mfma_f32_16x16x32_bf16 v[116:119], v[60:63], v[140:143], v[116:119]
    v_max_f32 v64, 0, v64
    v_max_f32 v65, 0, v65
    s_waitcnt lgkmcnt(5)
    v_mfma_f32_16x16x32_bf16 v[120:123], v[28:31], v[136:139], v[120:123]
    ds_read_b128 v[60:63], v24 offset:43264
    v_max_f32 v66, 0, v66
    v_mfma_f32_16x16x32_bf16 v[124:127], v[28:31], v[140:143], v[124:127]
    v_max_f32 v67, 0, v67
    v_max_f32 v68, 0, v68
    v_mfma_f32_16x16x32_bf16 v[112:115], v[32:35], v[144:147], v[112:115]
    ds_read_b128 v[28:31], v24 offset:45056
    v_max_f32 v69, 0, v69
    v_mfma_f32_16x16x32_bf16 v[116:119], v[32:35], v[148:151], v[116:119]
    buffer_load_dwordx4 v1, s[16:19], s85 offen offset:1024 sc1 lds
    v_max_f32 v70, 0, v70
    v_mfma_f32_16x16x32_bf16 v[120:123], v[36:39], v[144:147], v[120:123]
    ds_read_b128 v[32:35], v24 offset:45312
    v_max_f32 v71, 0, v71
    v_mfma_f32_16x16x32_bf16 v[124:127], v[36:39], v[148:151], v[124:127]
    v_mul_f32 v64, v64, v72
    s_waitcnt lgkmcnt(5)
    v_mfma_f32_16x16x32_bf16 v[112:115], v[40:43], v[152:155], v[112:115]
    ds_read_b128 v[36:39], v24 offset:47104
    v_mul_f32 v65, v65, v73
    v_mfma_f32_16x16x32_bf16 v[116:119], v[40:43], v[156:159], v[116:119]
    v_mul_f32 v66, v66, v74
    v_mul_f32 v67, v67, v75
    v_mfma_f32_16x16x32_bf16 v[120:123], v[44:47], v[152:155], v[120:123]
    ds_read_b128 v[40:43], v24 offset:47360
    v_mul_f32 v68, v68, v76
    v_mfma_f32_16x16x32_bf16 v[124:127], v[44:47], v[156:159], v[124:127]
    buffer_load_dwordx4 v1, s[16:19], s85 offen offset:2048 sc1 lds
    v_mul_f32 v69, v69, v77
    v_mfma_f32_16x16x32_bf16 v[112:115], v[48:51], v[160:163], v[112:115]
    ds_read_b128 v[44:47], v24 offset:49152
    v_mul_f32 v70, v70, v78
    v_mfma_f32_16x16x32_bf16 v[116:119], v[48:51], v[164:167], v[116:119]
    v_mul_f32 v71, v71, v79
    s_waitcnt lgkmcnt(5)
    v_mfma_f32_16x16x32_bf16 v[120:123], v[52:55], v[160:163], v[120:123]
    ds_read_b128 v[48:51], v24 offset:49408
    v_cvt_pk_bf16_f32 v12, v64, v65
    v_mfma_f32_16x16x32_bf16 v[124:127], v[52:55], v[164:167], v[124:127]
    v_cvt_pk_bf16_f32 v13, v66, v67
    v_cvt_pk_bf16_f32 v14, v68, v69
    v_mfma_f32_16x16x32_bf16 v[112:115], v[56:59], v[168:171], v[112:115]
    ds_read_b128 v[52:55], v24 offset:51200
    v_cvt_pk_bf16_f32 v15, v70, v71
    v_mfma_f32_16x16x32_bf16 v[116:119], v[56:59], v[172:175], v[116:119]
    buffer_load_dwordx4 v1, s[16:19], s85 offen offset:3072 sc1 lds
    v_mfma_f32_16x16x32_bf16 v[120:123], v[60:63], v[168:171], v[120:123]
    ds_read_b128 v[56:59], v24 offset:51456
    v_permlane16_swap_b32 v12, v14
    v_mfma_f32_16x16x32_bf16 v[124:127], v[60:63], v[172:175], v[124:127]
    v_permlane16_swap_b32 v13, v15
    s_waitcnt lgkmcnt(5)
    v_mfma_f32_16x16x32_bf16 v[112:115], v[28:31], v[176:179], v[112:115]
    ds_read_b128 v[60:63], v24 offset:53248
    buffer_store_dwordx4 v[12:15], v1, s[16:19], s28 offen offset:0 sc1
    v_mfma_f32_16x16x32_bf16 v[116:119], v[28:31], v[180:183], v[116:119]
    v_max_f32 v80, 0, v80
    v_max_f32 v81, 0, v81
    v_mfma_f32_16x16x32_bf16 v[120:123], v[32:35], v[176:179], v[120:123]
    ds_read_b128 v[28:31], v24 offset:53504
    v_max_f32 v82, 0, v82
    v_mfma_f32_16x16x32_bf16 v[124:127], v[32:35], v[180:183], v[124:127]
    s_add_u32 m0, s61, 49152
    s_add_u32 s85, s91, 196608
    buffer_load_dwordx4 v1, s[16:19], s85 offen offset:0 sc1 lds
    v_mfma_f32_16x16x32_bf16 v[112:115], v[36:39], v[184:187], v[112:115]
    ds_read_b128 v[32:35], v24 offset:55296
    v_max_f32 v83, 0, v83
    v_mfma_f32_16x16x32_bf16 v[116:119], v[36:39], v[188:191], v[116:119]
    v_max_f32 v84, 0, v84
    s_waitcnt lgkmcnt(5)
    v_mfma_f32_16x16x32_bf16 v[120:123], v[40:43], v[184:187], v[120:123]
    ds_read_b128 v[36:39], v24 offset:55552
    v_max_f32 v85, 0, v85
    v_mfma_f32_16x16x32_bf16 v[124:127], v[40:43], v[188:191], v[124:127]
    v_max_f32 v86, 0, v86
    v_max_f32 v87, 0, v87
    v_mfma_f32_16x16x32_bf16 v[112:115], v[44:47], v[192:195], v[112:115]
    ds_read_b128 v[40:43], v24 offset:57344
    v_mul_f32 v80, v80, v88
    v_mfma_f32_16x16x32_bf16 v[116:119], v[44:47], v[196:199], v[116:119]
    buffer_load_dwordx4 v1, s[16:19], s85 offen offset:1024 sc1 lds
    v_mul_f32 v81, v81, v89
    v_mfma_f32_16x16x32_bf16 v[120:123], v[48:51], v[192:195], v[120:123]
    ds_read_b128 v[44:47], v24 offset:57600
    v_mul_f32 v82, v82, v90
    v_mfma_f32_16x16x32_bf16 v[124:127], v[48:51], v[196:199], v[124:127]
    v_mul_f32 v83, v83, v91
    s_waitcnt lgkmcnt(5)
    v_mfma_f32_16x16x32_bf16 v[112:115], v[52:55], v[200:203], v[112:115]
    ds_read_b128 v[48:51], v24 offset:59392
    v_mul_f32 v84, v84, v92
    v_mfma_f32_16x16x32_bf16 v[116:119], v[52:55], v[204:207], v[116:119]
    buffer_load_dwordx4 v1, s[16:19], s85 offen offset:2048 sc1 lds
    v_mul_f32 v85, v85, v93
    v_mfma_f32_16x16x32_bf16 v[120:123], v[56:59], v[200:203], v[120:123]
    ds_read_b128 v[52:55], v24 offset:59648
    v_mul_f32 v86, v86, v94
    v_mfma_f32_16x16x32_bf16 v[124:127], v[56:59], v[204:207], v[124:127]
    v_mul_f32 v87, v87, v95
    v_cvt_pk_bf16_f32 v16, v80, v81
    v_mfma_f32_16x16x32_bf16 v[112:115], v[60:63], v[208:211], v[112:115]
    ds_read_b128 v[56:59], v24 offset:61440
    v_cvt_pk_bf16_f32 v17, v82, v83
    v_mfma_f32_16x16x32_bf16 v[116:119], v[60:63], v[212:215], v[116:119]
    v_cvt_pk_bf16_f32 v18, v84, v85
    s_waitcnt lgkmcnt(5)
    v_mfma_f32_16x16x32_bf16 v[120:123], v[28:31], v[208:211], v[120:123]
    ds_read_b128 v[60:63], v24 offset:61696
    v_cvt_pk_bf16_f32 v19, v86, v87
    v_mfma_f32_16x16x32_bf16 v[124:127], v[28:31], v[212:215], v[124:127]
    buffer_load_dwordx4 v1, s[16:19], s85 offen offset:3072 sc1 lds
    v_mfma_f32_16x16x32_bf16 v[112:115], v[32:35], v[216:219], v[112:115]
    ds_read_b128 v[28:31], v24 offset:63488
    v_permlane16_swap_b32 v16, v18
    v_mfma_f32_16x16x32_bf16 v[116:119], v[32:35], v[220:223], v[116:119]
    v_permlane16_swap_b32 v17, v19
    buffer_store_dwordx4 v[16:19], v1, s[16:19], s28 offen offset:1024 sc1
    v_mfma_f32_16x16x32_bf16 v[120:123], v[36:39], v[216:219], v[120:123]
    ds_read_b128 v[32:35], v24 offset:63744
    v_max_f32 v96, 0, v96
    v_mfma_f32_16x16x32_bf16 v[124:127], v[36:39], v[220:223], v[124:127]
    v_max_f32 v97, 0, v97
    s_waitcnt lgkmcnt(5)
    v_mfma_f32_16x16x32_bf16 v[112:115], v[40:43], v[224:227], v[112:115]
    ds_read_b128 v[36:39], v25 offset:0
    v_max_f32 v98, 0, v98
    v_mfma_f32_16x16x32_bf16 v[116:119], v[40:43], v[228:231], v[116:119]
    buffer_load_dwordx4 a[124:127], v6, s[16:19], s13 offen offset:0 sc1
    v_max_f32 v99, 0, v99
    v_mfma_f32_16x16x32_bf16 v[120:123], v[44:47], v[224:227], v[120:123]
    ds_read_b128 v[40:43], v25 offset:256
    v_max_f32 v100, 0, v100
    v_mfma_f32_16x16x32_bf16 v[124:127], v[44:47], v[228:231], v[124:127]
    v_max_f32 v101, 0, v101
    v_max_f32 v102, 0, v102
    v_mfma_f32_16x16x32_bf16 v[112:115], v[48:51], v[232:235], v[112:115]
    ds_read_b128 v[44:47], v25 offset:2048
    v_max_f32 v103, 0, v103
    v_mfma_f32_16x16x32_bf16 v[116:119], v[48:51], v[236:239], v[116:119]
    v_mul_f32 v96, v96, v104
    s_waitcnt lgkmcnt(5)
    v_mfma_f32_16x16x32_bf16 v[120:123], v[52:55], v[232:235], v[120:123]
    ds_read_b128 v[48:51], v25 offset:2304
    v_mul_f32 v97, v97, v105
    v_mfma_f32_16x16x32_bf16 v[124:127], v[52:55], v[236:239], v[124:127]
    buffer_load_dwordx4 a[128:131], v5, s[16:19], s10 offen offset:3072 sc1
    v_mul_f32 v98, v98, v106
    v_mfma_f32_16x16x32_bf16 v[112:115], v[56:59], v[240:243], v[112:115]
    ds_read_b128 v[52:55], v25 offset:4096
    v_mul_f32 v99, v99, v107
    v_mfma_f32_16x16x32_bf16 v[116:119], v[56:59], v[244:247], v[116:119]
    v_mul_f32 v100, v100, v108
    v_mul_f32 v101, v101, v109
    v_mfma_f32_16x16x4_4b_bf16 v[64:79], a[232:233], v[8:9], 0
    v_mfma_f32_16x16x32_bf16 v[120:123], v[60:63], v[240:243], v[120:123]
    ds_read_b128 v[56:59], v25 offset:4352
    buffer_load_dwordx4 a[132:135], v5, s[16:19], s14 offen offset:3072 sc1
    v_mfma_f32_16x16x32_bf16 v[124:127], v[60:63], v[244:247], v[124:127]
    v_mul_f32 v102, v102, v110
    s_waitcnt lgkmcnt(5)
    v_mfma_f32_16x16x32_bf16 v[112:115], v[28:31], v[248:251], v[112:115]
    ds_read_b128 v[60:63], v25 offset:6144
    v_mul_f32 v103, v103, v111
    v_mfma_f32_16x16x32_bf16 v[116:119], v[28:31], v[252:255], v[116:119]
    v_cvt_pk_bf16_f32 v12, v96, v97
    v_cvt_pk_bf16_f32 v13, v98, v99
    v_mfma_f32_16x16x32_bf16 v[120:123], v[32:35], v[248:251], v[120:123]
    ds_read_b128 v[28:31], v25 offset:6400
    v_cvt_pk_bf16_f32 v14, v100, v101
    v_mfma_f32_16x16x32_bf16 v[124:127], v[32:35], v[252:255], v[124:127]
    v_cvt_pk_bf16_f32 v15, v102, v103
    v_mfma_f32_16x16x32_bf16 v[64:67], v[36:39], v[128:131], v[64:67]
    ds_read_b128 v[32:35], v25 offset:8192
    buffer_load_dwordx4 a[136:139], v5, s[16:19], s11 offen offset:3072 sc1
    v_mfma_f32_16x16x32_bf16 v[68:71], v[36:39], v[132:135], v[68:71]
    v_permlane16_swap_b32 v12, v14
    s_waitcnt lgkmcnt(5)
    v_mfma_f32_16x16x32_bf16 v[72:75], v[40:43], v[128:131], v[72:75]
    ds_read_b128 v[36:39], v25 offset:8448
    v_permlane16_swap_b32 v13, v15
    v_mfma_f32_16x16x32_bf16 v[76:79], v[40:43], v[132:135], v[76:79]
    v_mfma_f32_16x16x4_4b_bf16 v[112:127], a[230:231], v[8:9], v[112:127]
    buffer_store_dwordx4 v[12:15], v1, s[16:19], s28 offen offset:2048 sc1
    v_mfma_f32_16x16x32_bf16 v[64:67], v[44:47], v[136:139], v[64:67]
    ds_read_b128 v[40:43], v25 offset:10240
    v_mfma_f32_16x16x32_bf16 v[68:71], v[44:47], v[140:143], v[68:71]
    v_mfma_f32_16x16x32_bf16 v[72:75], v[48:51], v[136:139], v[72:75]
    ds_read_b128 v[44:47], v25 offset:10496
    buffer_load_dwordx4 a[140:143], v5, s[16:19], s15 offen offset:3072 sc1
    v_mfma_f32_16x16x32_bf16 v[76:79], v[48:51], v[140:143], v[76:79]
    s_waitcnt lgkmcnt(5)
    v_mfma_f32_16x16x32_bf16 v[64:67], v[52:55], v[144:147], v[64:67]
    ds_read_b128 v[48:51], v25 offset:12288
    v_mfma_f32_16x16x32_bf16 v[68:71], v[52:55], v[148:151], v[68:71]
    v_max_f32 v112, 0, v112
    v_mfma_f32_16x16x32_bf16 v[72:75], v[56:59], v[144:147], v[72:75]
    ds_read_b128 v[52:55], v25 offset:12544
    v_max_f32 v113, 0, v113
    v_mfma_f32_16x16x32_bf16 v[76:79], v[56:59], v[148:151], v[76:79]
    v_max_f32 v114, 0, v114
    v_max_f32 v115, 0, v115
    v_mfma_f32_16x16x32_bf16 v[64:67], v[60:63], v[152:155], v[64:67]
    ds_read_b128 v[56:59], v25 offset:14336
    buffer_load_dwordx4 a[144:147], v6, s[16:19], s10 offen offset:0 sc1
    v_mfma_f32_16x16x32_bf16 v[68:71], v[60:63], v[156:159], v[68:71]
    v_max_f32 v116, 0, v116
    s_waitcnt lgkmcnt(5)
    v_mfma_f32_16x16x32_bf16 v[72:75], v[28:31], v[152:155], v[72:75]
    ds_read_b128 v[60:63], v25 offset:14592
    v_max_f32 v117, 0, v117
    v_mfma_f32_16x16x32_bf16 v[76:79], v[28:31], v[156:159], v[76:79]
    v_max_f32 v118, 0, v118
    v_max_f32 v119, 0, v119
    v_mfma_f32_16x16x32_bf16 v[64:67], v[32:35], v[160:163], v[64:67]
    ds_read_b128 v[28:31], v21 offset:0
    v_mul_f32 v112, v112, v120
    v_mfma_f32_16x16x32_bf16 v[68:71], v[32:35], v[164:167], v[68:71]
    v_mul_f32 v113, v113, v121
    v_mul_f32 v114, v114, v122
    v_mfma_f32_16x16x32_bf16 v[72:75], v[36:39], v[160:163], v[72:75]
    ds_read_b128 v[32:35], v21 offset:256
    buffer_load_dwordx4 a[148:151], v6, s[16:19], s14 offen offset:0 sc1
    v_mfma_f32_16x16x32_bf16 v[76:79], v[36:39], v[164:167], v[76:79]
    v_mul_f32 v115, v115, v123
    s_waitcnt lgkmcnt(5)
    v_mfma_f32_16x16x32_bf16 v[64:67], v[40:43], v[168:171], v[64:67]
    ds_read_b128 v[36:39], v21 offset:2048
    v_mul_f32 v116, v116, v124
    v_mfma_f32_16x16x32_bf16 v[68:71], v[40:43], v[172:175], v[68:71]
    v_mul_f32 v117, v117, v125
    v_mul_f32 v118, v118, v126
    v_mfma_f32_16x16x32_bf16 v[72:75], v[44:47], v[168:171], v[72:75]
    ds_read_b128 v[40:43], v21 offset:2304
    v_mul_f32 v119, v119, v127
    v_mfma_f32_16x16x32_bf16 v[76:79], v[44:47], v[172:175], v[76:79]
    buffer_load_dwordx4 a[152:155], v6, s[16:19], s11 offen offset:0 sc1
    v_cvt_pk_bf16_f32 v16, v112, v113
    v_mfma_f32_16x16x32_bf16 v[64:67], v[48:51], v[176:179], v[64:67]
    ds_read_b128 v[44:47], v21 offset:4096
    v_cvt_pk_bf16_f32 v17, v114, v115
    v_mfma_f32_16x16x32_bf16 v[68:71], v[48:51], v[180:183], v[68:71]
    v_cvt_pk_bf16_f32 v18, v116, v117
    s_waitcnt lgkmcnt(5)
    v_mfma_f32_16x16x32_bf16 v[72:75], v[52:55], v[176:179], v[72:75]
    ds_read_b128 v[48:51], v21 offset:4352
    v_cvt_pk_bf16_f32 v19, v118, v119
    v_mfma_f32_16x16x32_bf16 v[76:79], v[52:55], v[180:183], v[76:79]
    v_permlane16_swap_b32 v16, v18
    v_mfma_f32_16x16x32_bf16 v[64:67], v[56:59], v[184:187], v[64:67]
    ds_read_b128 v[52:55], v21 offset:6144
    v_permlane16_swap_b32 v17, v19
    v_mfma_f32_16x16x32_bf16 v[68:71], v[56:59], v[188:191], v[68:71]
    buffer_load_dwordx4 a[156:159], v6, s[16:19], s15 offen offset:0 sc1
    buffer_store_dwordx4 v[16:19], v1, s[16:19], s28 offen offset:3072 sc1
    v_mfma_f32_16x16x32_bf16 v[72:75], v[60:63], v[184:187], v[72:75]
    ds_read_b128 v[56:59], v21 offset:6400
    v_mfma_f32_16x16x32_bf16 v[76:79], v[60:63], v[188:191], v[76:79]
    s_waitcnt lgkmcnt(5)
    v_mfma_f32_16x16x32_bf16 v[64:67], v[28:31], v[192:195], v[64:67]
    ds_read_b128 v[60:63], v21 offset:8192
    v_mfma_f32_16x16x32_bf16 v[68:71], v[28:31], v[196:199], v[68:71]
    v_mfma_f32_16x16x32_bf16 v[72:75], v[32:35], v[192:195], v[72:75]
    ds_read_b128 v[28:31], v21 offset:8448
    v_mfma_f32_16x16x32_bf16 v[76:79], v[32:35], v[196:199], v[76:79]
    buffer_load_dwordx4 a[160:163], v6, s[16:19], s8 offen offset:1024 sc1
    v_mfma_f32_16x16x32_bf16 v[64:67], v[36:39], v[200:203], v[64:67]
    ds_read_b128 v[32:35], v21 offset:10240
    v_mfma_f32_16x16x32_bf16 v[68:71], v[36:39], v[204:207], v[68:71]
    s_waitcnt lgkmcnt(5)
    v_mfma_f32_16x16x32_bf16 v[72:75], v[40:43], v[200:203], v[72:75]
    ds_read_b128 v[36:39], v21 offset:10496
    v_mfma_f32_16x16x32_bf16 v[76:79], v[40:43], v[204:207], v[76:79]
    v_mfma_f32_16x16x32_bf16 v[64:67], v[44:47], v[208:211], v[64:67]
    ds_read_b128 v[40:43], v21 offset:12288
    v_mfma_f32_16x16x32_bf16 v[68:71], v[44:47], v[212:215], v[68:71]
    buffer_load_dwordx4 a[164:167], v6, s[16:19], s12 offen offset:1024 sc1
    v_mfma_f32_16x16x32_bf16 v[72:75], v[48:51], v[208:211], v[72:75]
    ds_read_b128 v[44:47], v21 offset:12544
    v_mfma_f32_16x16x32_bf16 v[76:79], v[48:51], v[212:215], v[76:79]
    s_waitcnt lgkmcnt(5)
    v_mfma_f32_16x16x32_bf16 v[64:67], v[52:55], v[216:219], v[64:67]
    ds_read_b128 v[48:51], v21 offset:14336
    v_mfma_f32_16x16x32_bf16 v[68:71], v[52:55], v[220:223], v[68:71]
    buffer_load_dwordx4 a[168:171], v6, s[16:19], s9 offen offset:1024 sc1
    v_mfma_f32_16x16x32_bf16 v[72:75], v[56:59], v[216:219], v[72:75]
    ds_read_b128 v[52:55], v21 offset:14592
    v_mfma_f32_16x16x32_bf16 v[76:79], v[56:59], v[220:223], v[76:79]
    s_waitcnt vmcnt(15)
    s_barrier
    v_mfma_f32_16x16x32_bf16 v[64:67], v[60:63], v[224:227], v[64:67]
    ds_read_b128 v[56:59], v21 offset:16384
    v_mfma_f32_16x16x32_bf16 v[68:71], v[60:63], v[228:231], v[68:71]
    s_waitcnt lgkmcnt(5)
    v_mfma_f32_16x16x32_bf16 v[72:75], v[28:31], v[224:227], v[72:75]
    ds_read_b128 v[60:63], v21 offset:16640
    v_mfma_f32_16x16x32_bf16 v[76:79], v[28:31], v[228:231], v[76:79]
    buffer_load_dwordx4 a[172:175], v6, s[16:19], s13 offen offset:1024 sc1
    v_mfma_f32_16x16x32_bf16 v[64:67], v[32:35], v[232:235], v[64:67]
    ds_read_b128 v[28:31], v21 offset:18432
    v_mfma_f32_16x16x32_bf16 v[68:71], v[32:35], v[236:239], v[68:71]
    v_mfma_f32_16x16x32_bf16 v[72:75], v[36:39], v[232:235], v[72:75]
    ds_read_b128 v[32:35], v21 offset:18688
    v_mfma_f32_16x16x32_bf16 v[76:79], v[36:39], v[236:239], v[76:79]
    s_waitcnt vmcnt(10)
    s_atomic_add s58, s[82:83], s29 offset:8
    s_waitcnt lgkmcnt(5)
    v_mfma_f32_16x16x32_bf16 v[64:67], v[40:43], v[240:243], v[64:67]
    ds_read_b128 v[36:39], v21 offset:20480
    v_mfma_f32_16x16x32_bf16 v[68:71], v[40:43], v[244:247], v[68:71]
    buffer_load_dwordx4 a[176:179], v6, s[16:19], s10 offen offset:1024 sc1
    v_mfma_f32_16x16x4_4b_bf16 v[80:95], a[234:235], v[8:9], 0
    v_mfma_f32_16x16x32_bf16 v[72:75], v[44:47], v[240:243], v[72:75]
    ds_read_b128 v[40:43], v21 offset:20736
    v_mfma_f32_16x16x32_bf16 v[76:79], v[44:47], v[244:247], v[76:79]
    v_mfma_f32_16x16x32_bf16 v[64:67], v[48:51], v[248:251], v[64:67]
    ds_read_b128 v[44:47], v21 offset:22528
    v_mfma_f32_16x16x32_bf16 v[68:71], v[48:51], v[252:255], v[68:71]
    s_waitcnt lgkmcnt(5)
    v_mfma_f32_16x16x32_bf16 v[72:75], v[52:55], v[248:251], v[72:75]
    ds_read_b128 v[48:51], v21 offset:22784
    v_mfma_f32_16x16x32_bf16 v[76:79], v[52:55], v[252:255], v[76:79]
    buffer_load_dwordx4 a[180:183], v6, s[16:19], s14 offen offset:1024 sc1
    v_mfma_f32_16x16x32_bf16 v[80:83], v[56:59], v[128:131], v[80:83]
    ds_read_b128 v[52:55], v21 offset:24576
    v_mfma_f32_16x16x32_bf16 v[84:87], v[56:59], v[132:135], v[84:87]
    v_mfma_f32_16x16x32_bf16 v[88:91], v[60:63], v[128:131], v[88:91]
    ds_read_b128 v[56:59], v21 offset:24832
    v_max_f32 v64, 0, v64
    v_mfma_f32_16x16x32_bf16 v[92:95], v[60:63], v[132:135], v[92:95]
    v_max_f32 v65, 0, v65
    s_waitcnt lgkmcnt(5)
    v_mfma_f32_16x16x32_bf16 v[80:83], v[28:31], v[136:139], v[80:83]
    ds_read_b128 v[60:63], v21 offset:26624
    v_max_f32 v66, 0, v66
    v_mfma_f32_16x16x32_bf16 v[84:87], v[28:31], v[140:143], v[84:87]
    buffer_load_dwordx4 a[184:187], v6, s[16:19], s11 offen offset:1024 sc1
    v_max_f32 v67, 0, v67
    v_mfma_f32_16x16x32_bf16 v[88:91], v[32:35], v[136:139], v[88:91]
    ds_read_b128 v[28:31], v21 offset:26880
    v_max_f32 v68, 0, v68
    v_mfma_f32_16x16x32_bf16 v[92:95], v[32:35], v[140:143], v[92:95]
    v_max_f32 v69, 0, v69
    v_max_f32 v70, 0, v70
    v_mfma_f32_16x16x32_bf16 v[80:83], v[36:39], v[144:147], v[80:83]
    ds_read_b128 v[32:35], v21 offset:28672
    buffer_load_dwordx4 a[188:191], v6, s[16:19], s15 offen offset:1024 sc1
    v_mfma_f32_16x16x32_bf16 v[84:87], v[36:39], v[148:151], v[84:87]
    v_max_f32 v71, 0, v71
    s_waitcnt lgkmcnt(5)
    v_mfma_f32_16x16x32_bf16 v[88:91], v[40:43], v[144:147], v[88:91]
    ds_read_b128 v[36:39], v21 offset:28928
    v_mul_f32 v64, v64, v72
    v_mfma_f32_16x16x32_bf16 v[92:95], v[40:43], v[148:151], v[92:95]
    v_mul_f32 v65, v65, v73
    v_mul_f32 v66, v66, v74
    v_mfma_f32_16x16x32_bf16 v[80:83], v[44:47], v[152:155], v[80:83]
    ds_read_b128 v[40:43], v21 offset:30720
    v_mul_f32 v67, v67, v75
    v_mfma_f32_16x16x32_bf16 v[84:87], v[44:47], v[156:159], v[84:87]
    v_mul_f32 v68, v68, v76
    v_mul_f32 v69, v69, v77
    v_mfma_f32_16x16x32_bf16 v[88:91], v[48:51], v[152:155], v[88:91]
    ds_read_b128 v[44:47], v21 offset:30976
    buffer_load_dwordx4 a[192:195], v6, s[16:19], s8 offen offset:2048 sc1
    v_mfma_f32_16x16x32_bf16 v[92:95], v[48:51], v[156:159], v[92:95]
    v_mul_f32 v70, v70, v78
    s_waitcnt lgkmcnt(5)
    v_mfma_f32_16x16x32_bf16 v[80:83], v[52:55], v[160:163], v[80:83]
    ds_read_b128 v[48:51], v21 offset:32768
    v_mul_f32 v71, v71, v79
    v_mfma_f32_16x16x32_bf16 v[84:87], v[52:55], v[164:167], v[84:87]
    v_cvt_pk_bf16_f32 v12, v64, v65
    v_cvt_pk_bf16_f32 v13, v66, v67
    v_mfma_f32_16x16x32_bf16 v[88:91], v[56:59], v[160:163], v[88:91]
    ds_read_b128 v[52:55], v21 offset:33024
    v_cvt_pk_bf16_f32 v14, v68, v69
    v_mfma_f32_16x16x32_bf16 v[92:95], v[56:59], v[164:167], v[92:95]
    v_cvt_pk_bf16_f32 v15, v70, v71
    v_mfma_f32_16x16x32_bf16 v[80:83], v[60:63], v[168:171], v[80:83]
    ds_read_b128 v[56:59], v21 offset:34816
    buffer_load_dwordx4 a[196:199], v6, s[16:19], s12 offen offset:2048 sc1
    v_mfma_f32_16x16x32_bf16 v[84:87], v[60:63], v[172:175], v[84:87]
    v_permlane16_swap_b32 v12, v14
    s_waitcnt lgkmcnt(5)
    v_mfma_f32_16x16x32_bf16 v[88:91], v[28:31], v[168:171], v[88:91]
    ds_read_b128 v[60:63], v21 offset:35072
    v_permlane16_swap_b32 v13, v15
    v_mfma_f32_16x16x32_bf16 v[92:95], v[28:31], v[172:175], v[92:95]
    buffer_store_dwordx4 v[12:15], v4, s[16:19], s28 offen offset:0 sc1
    v_mfma_f32_16x16x32_bf16 v[80:83], v[32:35], v[176:179], v[80:83]
    ds_read_b128 v[28:31], v21 offset:36864
    v_mfma_f32_16x16x32_bf16 v[84:87], v[32:35], v[180:183], v[84:87]
    v_mfma_f32_16x16x32_bf16 v[88:91], v[36:39], v[176:179], v[88:91]
    ds_read_b128 v[32:35], v21 offset:37120
    buffer_load_dwordx4 a[200:203], v6, s[16:19], s9 offen offset:2048 sc1
    v_mfma_f32_16x16x32_bf16 v[92:95], v[36:39], v[180:183], v[92:95]
    s_waitcnt lgkmcnt(5)
    v_mfma_f32_16x16x32_bf16 v[80:83], v[40:43], v[184:187], v[80:83]
    ds_read_b128 v[36:39], v21 offset:38912
    v_mfma_f32_16x16x32_bf16 v[84:87], v[40:43], v[188:191], v[84:87]
    v_mfma_f32_16x16x32_bf16 v[88:91], v[44:47], v[184:187], v[88:91]
    ds_read_b128 v[40:43], v21 offset:39168
    v_mfma_f32_16x16x32_bf16 v[92:95], v[44:47], v[188:191], v[92:95]
    buffer_load_dwordx4 a[204:207], v6, s[16:19], s13 offen offset:2048 sc1
    v_mfma_f32_16x16x32_bf16 v[80:83], v[48:51], v[192:195], v[80:83]
    ds_read_b128 v[44:47], v21 offset:40960
    v_mfma_f32_16x16x32_bf16 v[84:87], v[48:51], v[196:199], v[84:87]
    s_waitcnt lgkmcnt(5)
    v_mfma_f32_16x16x32_bf16 v[88:91], v[52:55], v[192:195], v[88:91]
    ds_read_b128 v[48:51], v21 offset:41216
    v_mfma_f32_16x16x32_bf16 v[92:95], v[52:55], v[196:199], v[92:95]
    v_mfma_f32_16x16x32_bf16 v[80:83], v[56:59], v[200:203], v[80:83]
    ds_read_b128 v[52:55], v21 offset:43008
    v_mfma_f32_16x16x32_bf16 v[84:87], v[56:59], v[204:207], v[84:87]
    buffer_load_dwordx4 a[208:211], v6, s[16:19], s10 offen offset:2048 sc1
    s_mov_b32 s65, 0
    s_atomic_umax s65, s[82:83], s72 offset:8 glc
    v_mfma_f32_16x16x32_bf16 v[88:91], v[60:63], v[200:203], v[88:91]
    ds_read_b128 v[56:59], v21 offset:43264
    v_mfma_f32_16x16x32_bf16 v[92:95], v[60:63], v[204:207], v[92:95]
    s_waitcnt lgkmcnt(5)
    v_mfma_f32_16x16x32_bf16 v[80:83], v[28:31], v[208:211], v[80:83]
    ds_read_b128 v[60:63], v21 offset:45056
    v_mfma_f32_16x16x32_bf16 v[84:87], v[28:31], v[212:215], v[84:87]
    v_mfma_f32_16x16x32_bf16 v[88:91], v[32:35], v[208:211], v[88:91]
    ds_read_b128 v[28:31], v21 offset:45312
    v_mfma_f32_16x16x32_bf16 v[92:95], v[32:35], v[212:215], v[92:95]
    buffer_load_dwordx4 a[212:215], v6, s[16:19], s14 offen offset:2048 sc1
    v_mfma_f32_16x16x32_bf16 v[80:83], v[36:39], v[216:219], v[80:83]
    ds_read_b128 v[32:35], v21 offset:47104
    v_mfma_f32_16x16x32_bf16 v[84:87], v[36:39], v[220:223], v[84:87]
    s_waitcnt lgkmcnt(5)
    v_mfma_f32_16x16x32_bf16 v[88:91], v[40:43], v[216:219], v[88:91]
    ds_read_b128 v[36:39], v21 offset:47360
    v_mfma_f32_16x16x32_bf16 v[92:95], v[40:43], v[220:223], v[92:95]
    v_mfma_f32_16x16x32_bf16 v[80:83], v[44:47], v[224:227], v[80:83]
    ds_read_b128 v[40:43], v21 offset:49152
    v_mfma_f32_16x16x32_bf16 v[84:87], v[44:47], v[228:231], v[84:87]
    buffer_load_dwordx4 a[216:219], v6, s[16:19], s11 offen offset:2048 sc1
    v_mfma_f32_16x16x32_bf16 v[88:91], v[48:51], v[224:227], v[88:91]
    ds_read_b128 v[44:47], v21 offset:49408
    v_mfma_f32_16x16x32_bf16 v[92:95], v[48:51], v[228:231], v[92:95]
    s_waitcnt lgkmcnt(5)
    v_mfma_f32_16x16x32_bf16 v[80:83], v[52:55], v[232:235], v[80:83]
    ds_read_b128 v[48:51], v21 offset:51200
    v_mfma_f32_16x16x32_bf16 v[84:87], v[52:55], v[236:239], v[84:87]
    v_mfma_f32_16x16x32_bf16 v[88:91], v[56:59], v[232:235], v[88:91]
    ds_read_b128 v[52:55], v21 offset:51456
    v_mfma_f32_16x16x32_bf16 v[92:95], v[56:59], v[236:239], v[92:95]
    buffer_load_dwordx4 a[220:223], v6, s[16:19], s15 offen offset:2048 sc1
    v_mfma_f32_16x16x32_bf16 v[80:83], v[60:63], v[240:243], v[80:83]
    ds_read_b128 v[56:59], v21 offset:53248
    v_mfma_f32_16x16x32_bf16 v[84:87], v[60:63], v[244:247], v[84:87]
    s_waitcnt lgkmcnt(5)
    v_mfma_f32_16x16x4_4b_bf16 v[96:111], a[236:237], v[8:9], 0
    v_mfma_f32_16x16x32_bf16 v[88:91], v[28:31], v[240:243], v[88:91]
    ds_read_b128 v[60:63], v21 offset:53504
    v_mfma_f32_16x16x32_bf16 v[92:95], v[28:31], v[244:247], v[92:95]
    v_mfma_f32_16x16x32_bf16 v[80:83], v[32:35], v[248:251], v[80:83]
    ds_read_b128 v[28:31], v21 offset:55296
    v_mfma_f32_16x16x32_bf16 v[84:87], v[32:35], v[252:255], v[84:87]
    v_mfma_f32_16x16x32_bf16 v[88:91], v[36:39], v[248:251], v[88:91]
    ds_read_b128 v[32:35], v21 offset:55552
    v_mfma_f32_16x16x32_bf16 v[92:95], v[36:39], v[252:255], v[92:95]
    s_waitcnt lgkmcnt(5)
    v_mfma_f32_16x16x32_bf16 v[96:99], v[40:43], v[128:131], v[96:99]
    ds_read_b128 v[36:39], v21 offset:57344
    v_mfma_f32_16x16x32_bf16 v[100:103], v[40:43], v[132:135], v[100:103]
    s_cmp_ge_u32 s65, 8
    s_cbranch_scc0 ps_31
pb_32:
    v_mfma_f32_16x16x32_bf16 v[104:107], v[44:47], v[128:131], v[104:107]
    ds_read_b128 v[40:43], v21 offset:57600
    v_mfma_f32_16x16x32_bf16 v[108:111], v[44:47], v[132:135], v[108:111]
    buffer_load_dwordx4 v[128:131], v5, s[16:19], s92 offen offset:0 sc1
    v_mfma_f32_16x16x32_bf16 v[96:99], v[48:51], v[136:139], v[96:99]
    ds_read_b128 v[44:47], v21 offset:59392
    v_max_f32 v80, 0, v80
    v_mfma_f32_16x16x32_bf16 v[100:103], v[48:51], v[140:143], v[100:103]
    v_max_f32 v81, 0, v81
    s_waitcnt lgkmcnt(5)
    v_mfma_f32_16x16x32_bf16 v[104:107], v[52:55], v[136:139], v[104:107]
    ds_read_b128 v[48:51], v21 offset:59648
    v_max_f32 v82, 0, v82
    v_mfma_f32_16x16x32_bf16 v[108:111], v[52:55], v[140:143], v[108:111]
    buffer_load_dwordx4 v[132:135], v5, s[16:19], s93 offen offset:0 sc1
    v_max_f32 v83, 0, v83
    v_mfma_f32_16x16x32_bf16 v[96:99], v[56:59], v[144:147], v[96:99]
    ds_read_b128 v[52:55], v21 offset:61440
    v_max_f32 v84, 0, v84
    v_mfma_f32_16x16x32_bf16 v[100:103], v[56:59], v[148:151], v[100:103]
    v_max_f32 v85, 0, v85
    v_max_f32 v86, 0, v86
    v_mfma_f32_16x16x32_bf16 v[104:107], v[60:63], v[144:147], v[104:107]
    ds_read_b128 v[56:59], v21 offset:61696
    v_max_f32 v87, 0, v87
    v_mfma_f32_16x16x32_bf16 v[108:111], v[60:63], v[148:151], v[108:111]
    buffer_load_dwordx4 v[136:139], v5, s[16:19], s96 offen offset:0 sc1
    s_waitcnt vmcnt(9)
    s_atomic_add s58, s[82:83], s29 offset:16392
    s_waitcnt lgkmcnt(5)
    v_mfma_f32_16x16x32_bf16 v[96:99], v[28:31], v[152:155], v[96:99]
    ds_read_b128 v[60:63], v21 offset:63488
    v_mul_f32 v80, v80, v88
    v_mfma_f32_16x16x32_bf16 v[100:103], v[28:31], v[156:159], v[100:103]
    v_mul_f32 v81, v81, v89
    v_mul_f32 v82, v82, v90
    v_mfma_f32_16x16x32_bf16 v[104:107], v[32:35], v[152:155], v[104:107]
    ds_read_b128 v[28:31], v21 offset:63744
    v_mul_f32 v83, v83, v91
    v_mfma_f32_16x16x32_bf16 v[108:111], v[32:35], v[156:159], v[108:111]
    buffer_load_dwordx4 v[140:143], v5, s[16:19], s97 offen offset:0 sc1
    v_mul_f32 v84, v84, v92
    v_mfma_f32_16x16x32_bf16 v[96:99], v[36:39], v[160:163], v[96:99]
    ds_read_b128 v[32:35], v24 offset:0
    v_mul_f32 v85, v85, v93
    v_mfma_f32_16x16x32_bf16 v[100:103], v[36:39], v[164:167], v[100:103]
    v_mul_f32 v86, v86, v94
    s_waitcnt lgkmcnt(5)
    v_mfma_f32_16x16x32_bf16 v[104:107], v[40:43], v[160:163], v[104:107]
    ds_read_b128 v[36:39], v24 offset:256
    v_mul_f32 v87, v87, v95
    v_mfma_f32_16x16x32_bf16 v[108:111], v[40:43], v[164:167], v[108:111]
    buffer_load_dwordx4 v[144:147], v5, s[16:19], s92 offen offset:1024 sc1
    v_cvt_pk_bf16_f32 v16, v80, v81
    v_mfma_f32_16x16x32_bf16 v[96:99], v[44:47], v[168:171], v[96:99]
    ds_read_b128 v[40:43], v24 offset:2048
    v_cvt_pk_bf16_f32 v17, v82, v83
    v_mfma_f32_16x16x32_bf16 v[100:103], v[44:47], v[172:175], v[100:103]
    v_cvt_pk_bf16_f32 v18, v84, v85
    v_cvt_pk_bf16_f32 v19, v86, v87
    v_mfma_f32_16x16x32_bf16 v[104:107], v[48:51], v[168:171], v[104:107]
    ds_read_b128 v[44:47], v24 offset:2304
    v_mfma_f32_16x16x32_bf16 v[108:111], v[48:51], v[172:175], v[108:111]
    buffer_load_dwordx4 v[148:151], v5, s[16:19], s93 offen offset:1024 sc1
    s_waitcnt lgkmcnt(5)
    v_mfma_f32_16x16x32_bf16 v[96:99], v[52:55], v[176:179], v[96:99]
    ds_read_b128 v[48:51], v24 offset:4096
    v_permlane16_swap_b32 v16, v18
    v_mfma_f32_16x16x32_bf16 v[100:103], v[52:55], v[180:183], v[100:103]
    v_permlane16_swap_b32 v17, v19
    buffer_store_dwordx4 v[16:19], v4, s[16:19], s28 offen offset:1024 sc1
    v_mfma_f32_16x16x32_bf16 v[104:107], v[56:59], v[176:179], v[104:107]
    ds_read_b128 v[52:55], v24 offset:4352
    v_mfma_f32_16x16x32_bf16 v[108:111], v[56:59], v[180:183], v[108:111]
    buffer_load_dwordx4 v[152:155], v5, s[16:19], s96 offen offset:1024 sc1
    v_mfma_f32_16x16x32_bf16 v[96:99], v[60:63], v[184:187], v[96:99]
    ds_read_b128 v[56:59], v24 offset:6144
    v_mfma_f32_16x16x32_bf16 v[100:103], v[60:63], v[188:191], v[100:103]
    s_waitcnt lgkmcnt(5)
    v_mfma_f32_16x16x32_bf16 v[104:107], v[28:31], v[184:187], v[104:107]
    ds_read_b128 v[60:63], v24 offset:6400
    v_mfma_f32_16x16x32_bf16 v[108:111], v[28:31], v[188:191], v[108:111]
    buffer_load_dwordx4 v[156:159], v5, s[16:19], s97 offen offset:1024 sc1
    v_mfma_f32_16x16x32_bf16 v[96:99], v[32:35], v[192:195], v[96:99]
    ds_read_b128 v[28:31], v24 offset:8192
    v_mfma_f32_16x16x32_bf16 v[100:103], v[32:35], v[196:199], v[100:103]
    v_mfma_f32_16x16x32_bf16 v[104:107], v[36:39], v[192:195], v[104:107]
    ds_read_b128 v[32:35], v24 offset:8448
    v_mfma_f32_16x16x32_bf16 v[108:111], v[36:39], v[196:199], v[108:111]
    buffer_load_dwordx4 v[160:163], v5, s[16:19], s92 offen offset:2048 sc1
    s_waitcnt lgkmcnt(5)
    v_mfma_f32_16x16x32_bf16 v[96:99], v[40:43], v[200:203], v[96:99]
    ds_read_b128 v[36:39], v24 offset:10240
    v_mfma_f32_16x16x32_bf16 v[100:103], v[40:43], v[204:207], v[100:103]
    v_mfma_f32_16x16x32_bf16 v[104:107], v[44:47], v[200:203], v[104:107]
    ds_read_b128 v[40:43], v24 offset:10496
    v_mfma_f32_16x16x32_bf16 v[108:111], v[44:47], v[204:207], v[108:111]
    buffer_load_dwordx4 v[164:167], v5, s[16:19], s93 offen offset:2048 sc1
    v_mfma_f32_16x16x32_bf16 v[96:99], v[48:51], v[208:211], v[96:99]
    ds_read_b128 v[44:47], v24 offset:12288
    v_mfma_f32_16x16x32_bf16 v[100:103], v[48:51], v[212:215], v[100:103]
    s_waitcnt lgkmcnt(5)
    v_mfma_f32_16x16x32_bf16 v[104:107], v[52:55], v[208:211], v[104:107]
    ds_read_b128 v[48:51], v24 offset:12544
    v_mfma_f32_16x16x32_bf16 v[108:111], v[52:55], v[212:215], v[108:111]
    buffer_load_dwordx4 v[168:171], v5, s[16:19], s96 offen offset:2048 sc1
    v_mfma_f32_16x16x32_bf16 v[96:99], v[56:59], v[216:219], v[96:99]
    ds_read_b128 v[52:55], v24 offset:14336
    v_mfma_f32_16x16x32_bf16 v[100:103], v[56:59], v[220:223], v[100:103]
    v_mfma_f32_16x16x32_bf16 v[104:107], v[60:63], v[216:219], v[104:107]
    ds_read_b128 v[56:59], v24 offset:14592
    v_mfma_f32_16x16x32_bf16 v[108:111], v[60:63], v[220:223], v[108:111]
    buffer_load_dwordx4 v[172:175], v5, s[16:19], s97 offen offset:2048 sc1
    s_waitcnt lgkmcnt(5)
    v_mfma_f32_16x16x32_bf16 v[96:99], v[28:31], v[224:227], v[96:99]
    v_mfma_f32_16x16x32_bf16 v[100:103], v[28:31], v[228:231], v[100:103]
    v_mfma_f32_16x16x32_bf16 v[104:107], v[32:35], v[224:227], v[104:107]
    v_mfma_f32_16x16x32_bf16 v[108:111], v[32:35], v[228:231], v[108:111]
    buffer_load_dwordx4 v[176:179], v5, s[16:19], s94 offen offset:0 sc1
    v_mfma_f32_16x16x32_bf16 v[96:99], v[36:39], v[232:235], v[96:99]
    v_mfma_f32_16x16x32_bf16 v[100:103], v[36:39], v[236:239], v[100:103]
    s_waitcnt lgkmcnt(2)
    v_mfma_f32_16x16x32_bf16 v[104:107], v[40:43], v[232:235], v[104:107]
    v_mfma_f32_16x16x32_bf16 v[108:111], v[40:43], v[236:239], v[108:111]
    buffer_load_dwordx4 v[180:183], v5, s[16:19], s95 offen offset:0 sc1
    v_mfma_f32_16x16x32_bf16 v[96:99], v[44:47], v[240:243], v[96:99]
    v_mfma_f32_16x16x32_bf16 v[100:103], v[44:47], v[244:247], v[100:103]
    v_mfma_f32_16x16x32_bf16 v[104:107], v[48:51], v[240:243], v[104:107]
    v_mfma_f32_16x16x32_bf16 v[108:111], v[48:51], v[244:247], v[108:111]
    buffer_load_dwordx4 v[184:187], v5, s[16:19], s98 offen offset:0 sc1
    s_waitcnt lgkmcnt(0)
    v_mfma_f32_16x16x32_bf16 v[96:99], v[52:55], v[248:251], v[96:99]
    v_mfma_f32_16x16x32_bf16 v[100:103], v[52:55], v[252:255], v[100:103]
    v_mfma_f32_16x16x32_bf16 v[104:107], v[56:59], v[248:251], v[104:107]
    v_mfma_f32_16x16x32_bf16 v[108:111], v[56:59], v[252:255], v[108:111]
    buffer_load_dwordx4 v[188:191], v5, s[16:19], s99 offen offset:0 sc1
    s_mov_b32 s66, 0
    s_atomic_umax s66, s[82:83], s72 offset:16392 glc
    s_waitcnt vmcnt(16)
    v_mfma_f32_16x16x32_bf16 v[64:67], a[0:3], v[128:131], 0
    v_max_f32 v96, 0, v96
    v_max_f32 v97, 0, v97
    v_max_f32 v98, 0, v98
    v_max_f32 v99, 0, v99
    v_max_f32 v100, 0, v100
    v_max_f32 v101, 0, v101
    v_max_f32 v102, 0, v102
    v_max_f32 v103, 0, v103
    v_mul_f32 v96, v96, v104
    v_mul_f32 v97, v97, v105
    s_waitcnt vmcnt(15)
    v_mfma_f32_16x16x32_bf16 v[68:71], a[0:3], v[132:135], 0
    v_mul_f32 v98, v98, v106
    v_mul_f32 v99, v99, v107
    v_mul_f32 v100, v100, v108
    v_mul_f32 v101, v101, v109
    v_mul_f32 v102, v102, v110
    v_mul_f32 v103, v103, v111
    v_cvt_pk_bf16_f32 v12, v96, v97
    v_cvt_pk_bf16_f32 v13, v98, v99
    v_cvt_pk_bf16_f32 v14, v100, v101
    v_cvt_pk_bf16_f32 v15, v102, v103
    s_nop 0
    v_permlane16_swap_b32 v12, v14
    v_mfma_f32_16x16x32_bf16 v[72:75], a[8:11], v[128:131], 0
    v_permlane16_swap_b32 v13, v15
    buffer_store_dwordx4 v[12:15], v4, s[16:19], s28 offen offset:2048 sc1
    v_mfma_f32_16x16x32_bf16 v[76:79], a[8:11], v[132:135], 0
    v_and_b32 v28, 31, v0
    v_mfma_f32_16x16x32_bf16 v[112:115], a[4:7], v[128:131], 0
    v_mfma_f32_16x16x32_bf16 v[116:119], a[4:7], v[132:135], 0
    buffer_load_dwordx4 v[192:195], v5, s[16:19], s94 offen offset:1024 sc1
    v_lshrrev_b32 v29, 5, v0
    v_mfma_f32_16x16x32_bf16 v[120:123], a[12:15], v[128:131], 0
    v_mfma_f32_16x16x32_bf16 v[124:127], a[12:15], v[132:135], 0
    v_lshlrev_b32 v28, 10, v28
    s_waitcnt vmcnt(16)
    v_mfma_f32_16x16x32_bf16 v[80:83], a[0:3], v[136:139], 0
    s_waitcnt vmcnt(15)
    v_mfma_f32_16x16x32_bf16 v[84:87], a[0:3], v[140:143], 0
    buffer_load_dwordx4 v[196:199], v5, s[16:19], s95 offen offset:1024 sc1
    v_lshl_add_u32 v28, v29, 4, v28
    v_mfma_f32_16x16x32_bf16 v[88:91], a[8:11], v[136:139], 0
    v_mfma_f32_16x16x32_bf16 v[92:95], a[8:11], v[140:143], 0
    v_add_u32 v29, 32768, v28
    s_waitcnt vmcnt(15)
    v_mfma_f32_16x16x32_bf16 v[64:67], a[16:19], v[144:147], v[64:67]
    s_waitcnt vmcnt(14)
    v_mfma_f32_16x16x32_bf16 v[68:71], a[16:19], v[148:151], v[68:71]
    s_waitcnt vmcnt(13)
    s_atomic_add s58, s[82:83], s29 offset:32776
    buffer_load_dwordx4 v[200:203], v5, s[16:19], s98 offen offset:1024 sc1
    v_xor_b32 v21, 2048, v20
    v_mfma_f32_16x16x32_bf16 v[72:75], a[24:27], v[144:147], v[72:75]
    v_mfma_f32_16x16x32_bf16 v[76:79], a[24:27], v[148:151], v[76:79]
    v_xor_b32 v22, 4096, v20
    v_mfma_f32_16x16x32_bf16 v[112:115], a[20:23], v[144:147], v[112:115]
    v_mfma_f32_16x16x32_bf16 v[116:119], a[20:23], v[148:151], v[116:119]
    buffer_load_dwordx4 v[204:207], v5, s[16:19], s99 offen offset:1024 sc1
    s_lshl3_add_u32 s31, s37, s32
    v_mfma_f32_16x16x32_bf16 v[120:123], a[28:31], v[144:147], v[120:123]
    v_mfma_f32_16x16x32_bf16 v[124:127], a[28:31], v[148:151], v[124:127]
    s_lshl_b32 s31, s31, 10
    s_waitcnt vmcnt(14)
    v_mfma_f32_16x16x32_bf16 v[80:83], a[16:19], v[152:155], v[80:83]
    s_waitcnt vmcnt(13)
    v_mfma_f32_16x16x32_bf16 v[84:87], a[16:19], v[156:159], v[84:87]
    buffer_load_dwordx4 v[208:211], v5, s[16:19], s94 offen offset:2048 sc1
    s_add_u32 s31, s31, 9699328
    v_mfma_f32_16x16x32_bf16 v[88:91], a[24:27], v[152:155], v[88:91]
    v_mfma_f32_16x16x32_bf16 v[92:95], a[24:27], v[156:159], v[92:95]
    buffer_load_dword v48, v27, s[16:19], s31 offen sc1
    v_mfma_f32_16x16x32_bf16 v[96:99], a[4:7], v[136:139], 0
    v_mfma_f32_16x16x32_bf16 v[100:103], a[4:7], v[140:143], 0
    buffer_load_dwordx4 v[212:215], v5, s[16:19], s95 offen offset:2048 sc1
    s_add_u32 s31, s31, 4096
    v_mfma_f32_16x16x32_bf16 v[104:107], a[12:15], v[136:139], 0
    v_mfma_f32_16x16x32_bf16 v[108:111], a[12:15], v[140:143], 0
    buffer_load_dword v50, v27, s[16:19], s31 offen sc1
    v_mfma_f32_16x16x32_bf16 v[96:99], a[20:23], v[152:155], v[96:99]
    v_mfma_f32_16x16x32_bf16 v[100:103], a[20:23], v[156:159], v[100:103]
    buffer_load_dwordx4 v[216:219], v5, s[16:19], s98 offen offset:2048 sc1
    v_mfma_f32_16x16x32_bf16 v[104:107], a[28:31], v[152:155], v[104:107]
    v_mfma_f32_16x16x32_bf16 v[108:111], a[28:31], v[156:159], v[108:111]
    v_accvgpr_read_b32 v33, a240
    s_waitcnt vmcnt(17)
    v_mfma_f32_16x16x32_bf16 v[64:67], a[32:35], v[160:163], v[64:67]
    s_waitcnt vmcnt(16)
    v_mfma_f32_16x16x32_bf16 v[68:71], a[32:35], v[164:167], v[68:71]
    buffer_load_dwordx4 v[220:223], v5, s[16:19], s99 offen offset:2048 sc1
    v_accvgpr_read_b32 v35, a241
    v_mfma_f32_16x16x32_bf16 v[112:115], a[36:39], v[160:163], v[112:115]
    v_mfma_f32_16x16x32_bf16 v[116:119], a[36:39], v[164:167], v[116:119]
    v_accvgpr_read_b32 v37, a242
    v_mfma_f32_16x16x32_bf16 v[72:75], a[40:43], v[160:163], v[72:75]
    v_mfma_f32_16x16x32_bf16 v[76:79], a[40:43], v[164:167], v[76:79]
    v_accvgpr_read_b32 v39, a243
    v_mfma_f32_16x16x32_bf16 v[120:123], a[44:47], v[160:163], v[120:123]
    v_mfma_f32_16x16x32_bf16 v[124:127], a[44:47], v[164:167], v[124:127]
    s_cmp_ge_u32 s66, 8
    s_cbranch_scc0 ps_33
pb_34:
    s_waitcnt vmcnt(16)
    v_mfma_f32_16x16x32_bf16 v[80:83], a[32:35], v[168:171], v[80:83]
    s_waitcnt vmcnt(15)
    v_mfma_f32_16x16x32_bf16 v[84:87], a[32:35], v[172:175], v[84:87]
    buffer_load_dwordx4 v[224:227], v5, s[16:19], s92 offen offset:3072 sc1
    v_mfma_f32_16x16x32_bf16 v[96:99], a[36:39], v[168:171], v[96:99]
    v_mfma_f32_16x16x32_bf16 v[100:103], a[36:39], v[172:175], v[100:103]
    v_permlane32_swap_b32 v33, v37
    v_mfma_f32_16x16x32_bf16 v[88:91], a[40:43], v[168:171], v[88:91]
    v_mfma_f32_16x16x32_bf16 v[92:95], a[40:43], v[172:175], v[92:95]
    buffer_load_dwordx4 v[228:231], v5, s[16:19], s93 offen offset:3072 sc1
    v_permlane32_swap_b32 v35, v39
    v_mfma_f32_16x16x32_bf16 v[104:107], a[44:47], v[168:171], v[104:107]
    v_mfma_f32_16x16x32_bf16 v[108:111], a[44:47], v[172:175], v[108:111]
    s_waitcnt vmcnt(16)
    v_mfma_f32_16x16x32_bf16 v[64:67], a[48:51], v[176:179], v[64:67]
    s_waitcnt vmcnt(15)
    v_mfma_f32_16x16x32_bf16 v[68:71], a[48:51], v[180:183], v[68:71]
    buffer_load_dwordx4 v[232:235], v5, s[16:19], s96 offen offset:3072 sc1
    v_mfma_f32_16x16x32_bf16 v[112:115], a[52:55], v[176:179], v[112:115]
    v_mfma_f32_16x16x32_bf16 v[116:119], a[52:55], v[180:183], v[116:119]
    v_permlane16_swap_b32 v33, v37
    v_mfma_f32_16x16x32_bf16 v[72:75], a[56:59], v[176:179], v[72:75]
    v_mfma_f32_16x16x32_bf16 v[76:79], a[56:59], v[180:183], v[76:79]
    buffer_load_dwordx4 v[236:239], v5, s[16:19], s97 offen offset:3072 sc1
    v_permlane16_swap_b32 v35, v39
    s_mov_b32 s67, 0
    s_atomic_umax s67, s[82:83], s72 offset:32776 glc
    v_mfma_f32_16x16x32_bf16 v[120:123], a[60:63], v[176:179], v[120:123]
    v_mfma_f32_16x16x32_bf16 v[124:127], a[60:63], v[180:183], v[124:127]
    s_waitcnt vmcnt(14)
    s_atomic_add s58, s[82:83], s29 offset:49160
    v_mfma_f32_16x16x32_bf16 v[80:83], a[48:51], v[184:187], v[80:83]
    v_mfma_f32_16x16x32_bf16 v[84:87], a[48:51], v[188:191], v[84:87]
    buffer_load_dwordx4 v[240:243], v6, s[16:19], s92 offen offset:0 sc1
    v_lshlrev_b32 v32, 16, v33
    v_mfma_f32_16x16x32_bf16 v[96:99], a[52:55], v[184:187], v[96:99]
    v_mfma_f32_16x16x32_bf16 v[100:103], a[52:55], v[188:191], v[100:103]
    v_and_b32 v33, 0xffff0000, v33
    v_mfma_f32_16x16x32_bf16 v[88:91], a[56:59], v[184:187], v[88:91]
    v_mfma_f32_16x16x32_bf16 v[92:95], a[56:59], v[188:191], v[92:95]
    buffer_load_dwordx4 v[244:247], v6, s[16:19], s93 offen offset:0 sc1
    v_mfma_f32_16x16x32_bf16 v[104:107], a[60:63], v[184:187], v[104:107]
    v_mfma_f32_16x16x32_bf16 v[108:111], a[60:63], v[188:191], v[108:111]
    v_lshlrev_b32 v34, 16, v35
    s_waitcnt vmcnt(15)
    v_mfma_f32_16x16x32_bf16 v[64:67], a[64:67], v[192:195], v[64:67]
    s_waitcnt vmcnt(14)
    v_mfma_f32_16x16x32_bf16 v[68:71], a[64:67], v[196:199], v[68:71]
    buffer_load_dwordx4 v[248:251], v6, s[16:19], s96 offen offset:0 sc1
    v_and_b32 v35, 0xffff0000, v35
    v_mfma_f32_16x16x32_bf16 v[112:115], a[68:71], v[192:195], v[112:115]
    v_mfma_f32_16x16x32_bf16 v[116:119], a[68:71], v[196:199], v[116:119]
    v_mfma_f32_16x16x32_bf16 v[72:75], a[72:75], v[192:195], v[72:75]
    v_mfma_f32_16x16x32_bf16 v[76:79], a[72:75], v[196:199], v[76:79]
    buffer_load_dwordx4 v[252:255], v6, s[16:19], s97 offen offset:0 sc1
    v_lshlrev_b32 v36, 16, v37
    v_mfma_f32_16x16x32_bf16 v[120:123], a[76:79], v[192:195], v[120:123]
    v_mfma_f32_16x16x32_bf16 v[124:127], a[76:79], v[196:199], v[124:127]
    v_and_b32 v37, 0xffff0000, v37
    s_waitcnt vmcnt(15)
    v_mfma_f32_16x16x32_bf16 v[80:83], a[64:67], v[200:203], v[80:83]
    s_waitcnt vmcnt(14)
    v_mfma_f32_16x16x32_bf16 v[84:87], a[64:67], v[204:207], v[84:87]
    buffer_load_dwordx4 v[128:131], v5, s[16:19], s94 offen offset:3072 sc1
    v_mfma_f32_16x16x32_bf16 v[96:99], a[68:71], v[200:203], v[96:99]
    v_mfma_f32_16x16x32_bf16 v[100:103], a[68:71], v[204:207], v[100:103]
    v_lshlrev_b32 v38, 16, v39
    v_mfma_f32_16x16x32_bf16 v[88:91], a[72:75], v[200:203], v[88:91]
    v_mfma_f32_16x16x32_bf16 v[92:95], a[72:75], v[204:207], v[92:95]
    buffer_load_dwordx4 v[132:135], v5, s[16:19], s95 offen offset:3072 sc1
    v_and_b32 v39, 0xffff0000, v39
    v_mfma_f32_16x16x32_bf16 v[104:107], a[76:79], v[200:203], v[104:107]
    v_mfma_f32_16x16x32_bf16 v[108:111], a[76:79], v[204:207], v[108:111]
    v_accvgpr_read_b32 v41, a244
    s_waitcnt vmcnt(15)
    v_mfma_f32_16x16x32_bf16 v[64:67], a[80:83], v[208:211], v[64:67]
    s_waitcnt vmcnt(13)
    v_mfma_f32_16x16x32_bf16 v[68:71], a[80:83], v[212:215], v[68:71]
    buffer_load_dwordx4 v[136:139], v5, s[16:19], s98 offen offset:3072 sc1
    v_accvgpr_read_b32 v43, a245
    v_mfma_f32_16x16x32_bf16 v[112:115], a[84:87], v[208:211], v[112:115]
    v_mfma_f32_16x16x32_bf16 v[116:119], a[84:87], v[212:215], v[116:119]
    v_accvgpr_read_b32 v45, a246
    v_mfma_f32_16x16x32_bf16 v[72:75], a[88:91], v[208:211], v[72:75]
    v_mfma_f32_16x16x32_bf16 v[76:79], a[88:91], v[212:215], v[76:79]
    buffer_load_dwordx4 v[140:143], v5, s[16:19], s99 offen offset:3072 sc1
    v_accvgpr_read_b32 v47, a247
    v_mfma_f32_16x16x32_bf16 v[120:123], a[92:95], v[208:211], v[120:123]
    v_mfma_f32_16x16x32_bf16 v[124:127], a[92:95], v[212:215], v[124:127]
    s_cmp_ge_u32 s67, 8
    s_cbranch_scc0 ps_35
pb_36:
    s_waitcnt vmcnt(13)
    v_mfma_f32_16x16x32_bf16 v[80:83], a[80:83], v[216:219], v[80:83]
    s_waitcnt vmcnt(12)
    v_mfma_f32_16x16x32_bf16 v[84:87], a[80:83], v[220:223], v[84:87]
    buffer_load_dwordx4 v[144:147], v6, s[16:19], s94 offen offset:0 sc1
    v_mfma_f32_16x16x32_bf16 v[96:99], a[84:87], v[216:219], v[96:99]
    v_mfma_f32_16x16x32_bf16 v[100:103], a[84:87], v[220:223], v[100:103]
    v_permlane32_swap_b32 v41, v45
    v_mfma_f32_16x16x32_bf16 v[88:91], a[88:91], v[216:219], v[88:91]
    v_mfma_f32_16x16x32_bf16 v[92:95], a[88:91], v[220:223], v[92:95]
    buffer_load_dwordx4 v[148:151], v6, s[16:19], s95 offen offset:0 sc1
    v_permlane32_swap_b32 v43, v47
    v_mfma_f32_16x16x32_bf16 v[104:107], a[92:95], v[216:219], v[104:107]
    v_mfma_f32_16x16x32_bf16 v[108:111], a[92:95], v[220:223], v[108:111]
    s_mov_b32 s68, 0
    s_atomic_umax s68, s[82:83], s72 offset:49160 glc
    s_waitcnt vmcnt(13)
    v_mfma_f32_16x16x32_bf16 v[64:67], a[96:99], v[224:227], v[64:67]
    s_waitcnt vmcnt(12)
    v_mfma_f32_16x16x32_bf16 v[68:71], a[96:99], v[228:231], v[68:71]
    buffer_load_dwordx4 v[152:155], v6, s[16:19], s98 offen offset:0 sc1
    v_mfma_f32_16x16x32_bf16 v[112:115], a[100:103], v[224:227], v[112:115]
    v_mfma_f32_16x16x32_bf16 v[116:119], a[100:103], v[228:231], v[116:119]
    v_permlane16_swap_b32 v41, v45
    v_mfma_f32_16x16x32_bf16 v[72:75], a[104:107], v[224:227], v[72:75]
    v_mfma_f32_16x16x32_bf16 v[76:79], a[104:107], v[228:231], v[76:79]
    buffer_load_dwordx4 v[156:159], v6, s[16:19], s99 offen offset:0 sc1
    v_permlane16_swap_b32 v43, v47
    v_mfma_f32_16x16x32_bf16 v[120:123], a[108:111], v[224:227], v[120:123]
    v_mfma_f32_16x16x32_bf16 v[124:127], a[108:111], v[228:231], v[124:127]
    s_waitcnt vmcnt(13)
    v_mfma_f32_16x16x32_bf16 v[80:83], a[96:99], v[232:235], v[80:83]
    s_waitcnt vmcnt(12)
    v_mfma_f32_16x16x32_bf16 v[84:87], a[96:99], v[236:239], v[84:87]
    buffer_load_dwordx4 v[160:163], v6, s[16:19], s92 offen offset:1024 sc1
    v_lshlrev_b32 v40, 16, v41
    v_mfma_f32_16x16x32_bf16 v[96:99], a[100:103], v[232:235], v[96:99]
    v_mfma_f32_16x16x32_bf16 v[100:103], a[100:103], v[236:239], v[100:103]
    v_and_b32 v41, 0xffff0000, v41
    v_mfma_f32_16x16x32_bf16 v[88:91], a[104:107], v[232:235], v[88:91]
    v_mfma_f32_16x16x32_bf16 v[92:95], a[104:107], v[236:239], v[92:95]
    buffer_load_dwordx4 v[164:167], v6, s[16:19], s93 offen offset:1024 sc1
    v_mfma_f32_16x16x32_bf16 v[104:107], a[108:111], v[232:235], v[104:107]
    v_mfma_f32_16x16x32_bf16 v[108:111], a[108:111], v[236:239], v[108:111]
    v_lshlrev_b32 v42, 16, v43
    s_waitcnt vmcnt(13)
    v_mfma_f32_16x16x32_bf16 v[64:67], a[112:115], v[240:243], v[64:67]
    s_waitcnt vmcnt(12)
    v_mfma_f32_16x16x32_bf16 v[68:71], a[112:115], v[244:247], v[68:71]
    buffer_load_dwordx4 v[168:171], v6, s[16:19], s96 offen offset:1024 sc1
    v_and_b32 v43, 0xffff0000, v43
    v_mfma_f32_16x16x32_bf16 v[112:115], a[116:119], v[240:243], v[112:115]
    v_mfma_f32_16x16x32_bf16 v[116:119], a[116:119], v[244:247], v[116:119]
    v_mfma_f32_16x16x32_bf16 v[72:75], a[120:123], v[240:243], v[72:75]
    v_mfma_f32_16x16x32_bf16 v[76:79], a[120:123], v[244:247], v[76:79]
    buffer_load_dwordx4 v[172:175], v6, s[16:19], s97 offen offset:1024 sc1
    v_lshlrev_b32 v44, 16, v45
    v_mfma_f32_16x16x32_bf16 v[120:123], a[124:127], v[240:243], v[120:123]
    v_mfma_f32_16x16x32_bf16 v[124:127], a[124:127], v[244:247], v[124:127]
    v_and_b32 v45, 0xffff0000, v45
    s_waitcnt vmcnt(13)
    v_mfma_f32_16x16x32_bf16 v[80:83], a[112:115], v[248:251], v[80:83]
    s_waitcnt vmcnt(12)
    v_mfma_f32_16x16x32_bf16 v[84:87], a[112:115], v[252:255], v[84:87]
    buffer_load_dwordx4 v[176:179], v6, s[16:19], s94 offen offset:1024 sc1
    v_mfma_f32_16x16x32_bf16 v[96:99], a[116:119], v[248:251], v[96:99]
    v_mfma_f32_16x16x32_bf16 v[100:103], a[116:119], v[252:255], v[100:103]
    v_lshlrev_b32 v46, 16, v47
    v_mfma_f32_16x16x32_bf16 v[88:91], a[120:123], v[248:251], v[88:91]
    v_mfma_f32_16x16x32_bf16 v[92:95], a[120:123], v[252:255], v[92:95]
    buffer_load_dwordx4 v[180:183], v6, s[16:19], s95 offen offset:1024 sc1
    v_and_b32 v47, 0xffff0000, v47
    v_mfma_f32_16x16x32_bf16 v[104:107], a[124:127], v[248:251], v[104:107]
    v_mfma_f32_16x16x32_bf16 v[108:111], a[124:127], v[252:255], v[108:111]
    s_waitcnt vmcnt(13)
    v_mfma_f32_16x16x32_bf16 v[112:115], a[132:135], v[128:131], v[112:115]
    s_waitcnt vmcnt(12)
    v_mfma_f32_16x16x32_bf16 v[116:119], a[132:135], v[132:135], v[116:119]
    buffer_load_dwordx4 v[184:187], v6, s[16:19], s98 offen offset:1024 sc1
    v_mov_b32 v49, v48
    s_cmp_ge_u32 s68, 8
    s_cbranch_scc0 ps_37
pb_38:
    v_mfma_f32_16x16x32_bf16 v[72:75], a[136:139], v[128:131], v[72:75]
    v_mfma_f32_16x16x32_bf16 v[76:79], a[136:139], v[132:135], v[76:79]
    v_mov_b32 v51, v50
    v_mfma_f32_16x16x32_bf16 v[120:123], a[140:143], v[128:131], v[120:123]
    v_mfma_f32_16x16x32_bf16 v[124:127], a[140:143], v[132:135], v[124:127]
    buffer_load_dwordx4 v[188:191], v6, s[16:19], s99 offen offset:1024 sc1
    v_permlane16_swap_b32 v48, v49
    s_waitcnt vmcnt(13)
    v_mfma_f32_16x16x32_bf16 v[96:99], a[132:135], v[136:139], v[96:99]
    s_waitcnt vmcnt(12)
    v_mfma_f32_16x16x32_bf16 v[100:103], a[132:135], v[140:143], v[100:103]
    buffer_load_dwordx4 v[192:195], v6, s[16:19], s92 offen offset:2048 sc1
    v_permlane16_swap_b32 v50, v51
    v_mfma_f32_16x16x32_bf16 v[88:91], a[136:139], v[136:139], v[88:91]
    v_mfma_f32_16x16x32_bf16 v[92:95], a[136:139], v[140:143], v[92:95]
    buffer_load_dwordx4 v[196:199], v6, s[16:19], s93 offen offset:2048 sc1
    v_mfma_f32_16x16x32_bf16 v[104:107], a[140:143], v[136:139], v[104:107]
    v_mfma_f32_16x16x32_bf16 v[108:111], a[140:143], v[140:143], v[108:111]
    buffer_load_dwordx4 v[200:203], v6, s[16:19], s94 offen offset:2048 sc1
    s_waitcnt vmcnt(14)
    v_mfma_f32_16x16x32_bf16 v[112:115], a[148:151], v[144:147], v[112:115]
    s_waitcnt vmcnt(13)
    v_mfma_f32_16x16x32_bf16 v[116:119], a[148:151], v[148:151], v[116:119]
    buffer_load_dwordx4 v[204:207], v6, s[16:19], s95 offen offset:2048 sc1
    v_mfma_f32_16x16x32_bf16 v[72:75], a[152:155], v[144:147], v[72:75]
    v_mfma_f32_16x16x32_bf16 v[76:79], a[152:155], v[148:151], v[76:79]
    buffer_load_dwordx4 v[208:211], v6, s[16:19], s96 offen offset:2048 sc1
    v_mfma_f32_16x16x32_bf16 v[120:123], a[156:159], v[144:147], v[120:123]
    v_mfma_f32_16x16x32_bf16 v[124:127], a[156:159], v[148:151], v[124:127]
    buffer_load_dwordx4 v[212:215], v6, s[16:19], s97 offen offset:2048 sc1
    s_waitcnt vmcnt(15)
    v_mfma_f32_16x16x32_bf16 v[96:99], a[148:151], v[152:155], v[96:99]
    s_waitcnt vmcnt(14)
    v_mfma_f32_16x16x32_bf16 v[100:103], a[148:151], v[156:159], v[100:103]
    buffer_load_dwordx4 v[216:219], v6, s[16:19], s98 offen offset:2048 sc1
    v_mfma_f32_16x16x32_bf16 v[88:91], a[152:155], v[152:155], v[88:91]
    v_mfma_f32_16x16x32_bf16 v[92:95], a[152:155], v[156:159], v[92:95]
    buffer_load_dwordx4 v[220:223], v6, s[16:19], s99 offen offset:2048 sc1
    v_mfma_f32_16x16x32_bf16 v[104:107], a[156:159], v[152:155], v[104:107]
    v_mfma_f32_16x16x32_bf16 v[108:111], a[156:159], v[156:159], v[108:111]
    s_waitcnt vmcnt(15)
    v_mfma_f32_16x16x32_bf16 v[112:115], a[164:167], v[160:163], v[112:115]
    s_waitcnt vmcnt(14)
    v_mfma_f32_16x16x32_bf16 v[116:119], a[164:167], v[164:167], v[116:119]
    v_mfma_f32_16x16x32_bf16 v[72:75], a[168:171], v[160:163], v[72:75]
    v_mfma_f32_16x16x32_bf16 v[76:79], a[168:171], v[164:167], v[76:79]
    v_mfma_f32_16x16x32_bf16 v[120:123], a[172:175], v[160:163], v[120:123]
    v_mfma_f32_16x16x32_bf16 v[124:127], a[172:175], v[164:167], v[124:127]
    s_waitcnt vmcnt(13)
    v_mfma_f32_16x16x32_bf16 v[96:99], a[164:167], v[168:171], v[96:99]
    s_waitcnt vmcnt(12)
    v_mfma_f32_16x16x32_bf16 v[100:103], a[164:167], v[172:175], v[100:103]
    v_mfma_f32_16x16x32_bf16 v[88:91], a[168:171], v[168:171], v[88:91]
    v_mfma_f32_16x16x32_bf16 v[92:95], a[168:171], v[172:175], v[92:95]
    v_mfma_f32_16x16x32_bf16 v[104:107], a[172:175], v[168:171], v[104:107]
    v_mfma_f32_16x16x32_bf16 v[108:111], a[172:175], v[172:175], v[108:111]
    s_waitcnt vmcnt(11)
    v_mfma_f32_16x16x32_bf16 v[112:115], a[180:183], v[176:179], v[112:115]
    s_waitcnt vmcnt(10)
    v_mfma_f32_16x16x32_bf16 v[116:119], a[180:183], v[180:183], v[116:119]
    v_mfma_f32_16x16x32_bf16 v[72:75], a[184:187], v[176:179], v[72:75]
    v_mfma_f32_16x16x32_bf16 v[76:79], a[184:187], v[180:183], v[76:79]
    v_mfma_f32_16x16x32_bf16 v[120:123], a[188:191], v[176:179], v[120:123]
    v_mfma_f32_16x16x32_bf16 v[124:127], a[188:191], v[180:183], v[124:127]
    s_waitcnt vmcnt(9)
    v_mfma_f32_16x16x32_bf16 v[96:99], a[180:183], v[184:187], v[96:99]
    s_waitcnt vmcnt(8)
    v_mfma_f32_16x16x32_bf16 v[100:103], a[180:183], v[188:191], v[100:103]
    v_mfma_f32_16x16x32_bf16 v[88:91], a[184:187], v[184:187], v[88:91]
    v_mfma_f32_16x16x32_bf16 v[92:95], a[184:187], v[188:191], v[92:95]
    v_mfma_f32_16x16x32_bf16 v[104:107], a[188:191], v[184:187], v[104:107]
    v_mfma_f32_16x16x32_bf16 v[108:111], a[188:191], v[188:191], v[108:111]
    s_waitcnt vmcnt(7)
    v_mfma_f32_16x16x32_bf16 v[112:115], a[196:199], v[192:195], v[112:115]
    s_waitcnt vmcnt(6)
    v_mfma_f32_16x16x32_bf16 v[116:119], a[196:199], v[196:199], v[116:119]
    v_mfma_f32_16x16x32_bf16 v[120:123], a[204:207], v[192:195], v[120:123]
    v_mfma_f32_16x16x32_bf16 v[124:127], a[204:207], v[196:199], v[124:127]
    s_waitcnt vmcnt(5)
    v_mfma_f32_16x16x32_bf16 v[112:115], a[212:215], v[200:203], v[112:115]
    s_waitcnt vmcnt(4)
    v_mfma_f32_16x16x32_bf16 v[116:119], a[212:215], v[204:207], v[116:119]
    v_mfma_f32_16x16x32_bf16 v[120:123], a[220:223], v[200:203], v[120:123]
    v_mfma_f32_16x16x32_bf16 v[124:127], a[220:223], v[204:207], v[124:127]
    s_waitcnt vmcnt(3)
    v_mfma_f32_16x16x32_bf16 v[96:99], a[196:199], v[208:211], v[96:99]
    s_waitcnt vmcnt(2)
    v_mfma_f32_16x16x32_bf16 v[100:103], a[196:199], v[212:215], v[100:103]
    v_mfma_f32_16x16x32_bf16 v[104:107], a[204:207], v[208:211], v[104:107]
    v_mfma_f32_16x16x32_bf16 v[108:111], a[204:207], v[212:215], v[108:111]
    ds_write_b128 v21, v[112:115] offset:0
    s_waitcnt vmcnt(1)
    v_mfma_f32_16x16x32_bf16 v[96:99], a[212:215], v[216:219], v[96:99]
    s_waitcnt vmcnt(0)
    v_mfma_f32_16x16x32_bf16 v[100:103], a[212:215], v[220:223], v[100:103]
    ds_write_b128 v21, v[116:119] offset:1024
    v_mfma_f32_16x16x32_bf16 v[104:107], a[220:223], v[216:219], v[104:107]
    v_mfma_f32_16x16x32_bf16 v[108:111], a[220:223], v[220:223], v[108:111]
    ds_write_b128 v23, v[120:123] offset:16384
    v_mfma_f32_16x16x32_bf16 v[72:75], a[200:203], v[192:195], v[72:75]
    v_mfma_f32_16x16x32_bf16 v[76:79], a[200:203], v[196:199], v[76:79]
    ds_write_b128 v23, v[124:127] offset:17408
    v_mfma_f32_16x16x32_bf16 v[72:75], a[216:219], v[200:203], v[72:75]
    v_mfma_f32_16x16x32_bf16 v[76:79], a[216:219], v[204:207], v[76:79]
    ds_write_b128 v21, v[96:99] offset:24576
    v_mfma_f32_16x16x32_bf16 v[88:91], a[200:203], v[208:211], v[88:91]
    v_mfma_f32_16x16x32_bf16 v[92:95], a[200:203], v[212:215], v[92:95]
    ds_write_b128 v21, v[100:103] offset:25600
    v_mfma_f32_16x16x32_bf16 v[88:91], a[216:219], v[216:219], v[88:91]
    v_mfma_f32_16x16x32_bf16 v[92:95], a[216:219], v[220:223], v[92:95]
    ds_write_b128 v23, v[104:107] offset:40960
    v_mfma_f32_16x16x32_bf16 v[64:67], a[192:195], v[192:195], v[64:67]
    v_mfma_f32_16x16x32_bf16 v[68:71], a[192:195], v[196:199], v[68:71]
    ds_write_b128 v23, v[108:111] offset:41984
    v_mfma_f32_16x16x32_bf16 v[64:67], a[208:211], v[200:203], v[64:67]
    v_mfma_f32_16x16x32_bf16 v[68:71], a[208:211], v[204:207], v[68:71]
    ds_write_b128 v22, v[72:75] offset:8192
    v_mfma_f32_16x16x32_bf16 v[80:83], a[192:195], v[208:211], v[80:83]
    v_mfma_f32_16x16x32_bf16 v[84:87], a[192:195], v[212:215], v[84:87]
    ds_write_b128 v22, v[76:79] offset:9216
    v_mfma_f32_16x16x32_bf16 v[80:83], a[208:211], v[216:219], v[80:83]
    v_mfma_f32_16x16x32_bf16 v[84:87], a[208:211], v[220:223], v[84:87]
    ds_write_b128 v22, v[88:91] offset:32768
    v_mfma_f32_16x16x32_bf16 v[64:67], a[128:131], v[128:131], v[64:67]
    v_mfma_f32_16x16x32_bf16 v[68:71], a[128:131], v[132:135], v[68:71]
    ds_write_b128 v22, v[92:95] offset:33792
    v_mfma_f32_16x16x32_bf16 v[80:83], a[128:131], v[136:139], v[80:83]
    v_mfma_f32_16x16x32_bf16 v[84:87], a[128:131], v[140:143], v[84:87]
    v_mfma_f32_16x16x32_bf16 v[64:67], a[144:147], v[144:147], v[64:67]
    v_mfma_f32_16x16x32_bf16 v[68:71], a[144:147], v[148:151], v[68:71]
    s_waitcnt lgkmcnt(0)
    s_barrier
    ds_read_b128 v[112:115], v20 offset:0
    ds_read_b128 v[116:119], v20 offset:1024
    v_mfma_f32_16x16x32_bf16 v[80:83], a[144:147], v[152:155], v[80:83]
    ds_read_b128 v[120:123], v20 offset:8192
    ds_read_b128 v[124:127], v20 offset:9216
    v_mfma_f32_16x16x32_bf16 v[84:87], a[144:147], v[156:159], v[84:87]
    ds_read_b128 v[72:75], v20 offset:16384
    ds_read_b128 v[76:79], v20 offset:17408
    v_mfma_f32_16x16x32_bf16 v[64:67], a[160:163], v[160:163], v[64:67]
    ds_read_b128 v[96:99], v20 offset:24576
    ds_read_b128 v[100:103], v20 offset:25600
    v_mfma_f32_16x16x32_bf16 v[68:71], a[160:163], v[164:167], v[68:71]
    ds_read_b128 v[104:107], v20 offset:32768
    ds_read_b128 v[108:111], v20 offset:33792
    v_mfma_f32_16x16x32_bf16 v[80:83], a[160:163], v[168:171], v[80:83]
    ds_read_b128 v[88:91], v20 offset:40960
    ds_read_b128 v[92:95], v20 offset:41984
    v_mfma_f32_16x16x32_bf16 v[84:87], a[160:163], v[172:175], v[84:87]
    s_waitcnt lgkmcnt(10)
    v_fmac_f32 v32, v112, v48
    v_mfma_f32_16x16x32_bf16 v[64:67], a[176:179], v[176:179], v[64:67]
    v_fmac_f32 v33, v113, v48
    v_fmac_f32 v34, v114, v48
    v_mfma_f32_16x16x32_bf16 v[68:71], a[176:179], v[180:183], v[68:71]
    v_fmac_f32 v35, v115, v48
    v_fmac_f32 v36, v116, v49
    v_mfma_f32_16x16x32_bf16 v[80:83], a[176:179], v[184:187], v[80:83]
    v_fmac_f32 v37, v117, v49
    v_fmac_f32 v38, v118, v49
    v_mfma_f32_16x16x32_bf16 v[84:87], a[176:179], v[188:191], v[84:87]
    v_fmac_f32 v39, v119, v49
    s_waitcnt lgkmcnt(8)
    v_pk_fma_f32 v[32:33], v[120:121], v[48:49], v[32:33] op_sel:[0,0,0] op_sel_hi:[1,0,1]
    v_pk_fma_f32 v[34:35], v[122:123], v[48:49], v[34:35] op_sel:[0,0,0] op_sel_hi:[1,0,1]
    v_pk_fma_f32 v[36:37], v[124:125], v[48:49], v[36:37] op_sel:[0,1,0] op_sel_hi:[1,1,1]
    v_pk_fma_f32 v[38:39], v[126:127], v[48:49], v[38:39] op_sel:[0,1,0] op_sel_hi:[1,1,1]
    s_waitcnt lgkmcnt(6)
    v_pk_fma_f32 v[32:33], v[72:73], v[48:49], v[32:33] op_sel:[0,0,0] op_sel_hi:[1,0,1]
    v_pk_fma_f32 v[34:35], v[74:75], v[48:49], v[34:35] op_sel:[0,0,0] op_sel_hi:[1,0,1]
    v_pk_fma_f32 v[36:37], v[76:77], v[48:49], v[36:37] op_sel:[0,1,0] op_sel_hi:[1,1,1]
    v_pk_fma_f32 v[38:39], v[78:79], v[48:49], v[38:39] op_sel:[0,1,0] op_sel_hi:[1,1,1]
    v_pk_fma_f32 v[64:65], v[64:65], v[48:49], v[32:33] op_sel:[0,0,0] op_sel_hi:[1,0,1]
    v_pk_fma_f32 v[66:67], v[66:67], v[48:49], v[34:35] op_sel:[0,0,0] op_sel_hi:[1,0,1]
    v_pk_fma_f32 v[68:69], v[68:69], v[48:49], v[36:37] op_sel:[0,1,0] op_sel_hi:[1,1,1]
    v_pk_fma_f32 v[70:71], v[70:71], v[48:49], v[38:39] op_sel:[0,1,0] op_sel_hi:[1,1,1]
    v_cvt_pk_bf16_f32 v64, v64, v65
    v_cvt_pk_bf16_f32 v65, v66, v67
    v_cvt_pk_bf16_f32 v66, v68, v69
    v_cvt_pk_bf16_f32 v67, v70, v71
    s_nop 0
    v_permlane16_swap_b32 v64, v66
    v_permlane16_swap_b32 v65, v67
    buffer_store_dwordx4 v[64:67], v28, s[20:23], s86 offen
    s_waitcnt lgkmcnt(4)
    v_pk_fma_f32 v[40:41], v[96:97], v[50:51], v[40:41] op_sel:[0,0,0] op_sel_hi:[1,0,1]
    v_pk_fma_f32 v[42:43], v[98:99], v[50:51], v[42:43] op_sel:[0,0,0] op_sel_hi:[1,0,1]
    v_pk_fma_f32 v[44:45], v[100:101], v[50:51], v[44:45] op_sel:[0,1,0] op_sel_hi:[1,1,1]
    v_pk_fma_f32 v[46:47], v[102:103], v[50:51], v[46:47] op_sel:[0,1,0] op_sel_hi:[1,1,1]
    s_waitcnt lgkmcnt(2)
    v_pk_fma_f32 v[40:41], v[104:105], v[50:51], v[40:41] op_sel:[0,0,0] op_sel_hi:[1,0,1]
    v_pk_fma_f32 v[42:43], v[106:107], v[50:51], v[42:43] op_sel:[0,0,0] op_sel_hi:[1,0,1]
    v_pk_fma_f32 v[44:45], v[108:109], v[50:51], v[44:45] op_sel:[0,1,0] op_sel_hi:[1,1,1]
    v_pk_fma_f32 v[46:47], v[110:111], v[50:51], v[46:47] op_sel:[0,1,0] op_sel_hi:[1,1,1]
    s_waitcnt lgkmcnt(0)
    v_pk_fma_f32 v[40:41], v[88:89], v[50:51], v[40:41] op_sel:[0,0,0] op_sel_hi:[1,0,1]
    v_pk_fma_f32 v[42:43], v[90:91], v[50:51], v[42:43] op_sel:[0,0,0] op_sel_hi:[1,0,1]
    v_pk_fma_f32 v[44:45], v[92:93], v[50:51], v[44:45] op_sel:[0,1,0] op_sel_hi:[1,1,1]
    v_pk_fma_f32 v[46:47], v[94:95], v[50:51], v[46:47] op_sel:[0,1,0] op_sel_hi:[1,1,1]
    v_pk_fma_f32 v[80:81], v[80:81], v[50:51], v[40:41] op_sel:[0,0,0] op_sel_hi:[1,0,1]
    v_pk_fma_f32 v[82:83], v[82:83], v[50:51], v[42:43] op_sel:[0,0,0] op_sel_hi:[1,0,1]
    v_pk_fma_f32 v[84:85], v[84:85], v[50:51], v[44:45] op_sel:[0,1,0] op_sel_hi:[1,1,1]
    v_pk_fma_f32 v[86:87], v[86:87], v[50:51], v[46:47] op_sel:[0,1,0] op_sel_hi:[1,1,1]
    v_cvt_pk_bf16_f32 v80, v80, v81
    v_cvt_pk_bf16_f32 v81, v82, v83
    v_cvt_pk_bf16_f32 v82, v84, v85
    v_cvt_pk_bf16_f32 v83, v86, v87
    s_nop 0
    v_permlane16_swap_b32 v80, v82
    v_permlane16_swap_b32 v81, v83
    buffer_store_dwordx4 v[80:83], v29, s[20:23], s86 offen
    s_waitcnt vmcnt(0)
L_end:
    s_endpgm
L_hot:
ps_5:
    s_mov_b32 s57, 0
pl_7:
    global_load_dword v58, v2, s[80:81] sc1
    s_waitcnt vmcnt(0)
    v_cmp_le_u32 vcc, 41, v58
    s_cbranch_vccnz pb_6
    s_add_u32 s57, s57, 1
    s_cmp_lt_u32 s57, 20000
    s_cbranch_scc1 pl_7
    s_branch pb_6
ps_8:
    s_mov_b32 s57, 0
pl_39:
    s_waitcnt lgkmcnt(0)
    s_cmp_ge_u32 s62, s67
    s_cbranch_scc1 pb_9
    s_atomic_umax s62, s[82:83], s59 offset:0 glc
    s_add_u32 s57, s57, 1
    s_cmp_lt_u32 s57, 20000
    s_cbranch_scc1 pl_39
    s_waitcnt lgkmcnt(0)
    s_branch pb_9
ps_10:
    s_mov_b32 s57, 0
pl_40:
    s_waitcnt lgkmcnt(0)
    s_cmp_ge_u32 s63, s67
    s_cbranch_scc1 pb_11
    s_atomic_umax s63, s[82:83], s59 offset:12 glc
    s_add_u32 s57, s57, 1
    s_cmp_lt_u32 s57, 20000
    s_cbranch_scc1 pl_40
    s_waitcnt lgkmcnt(0)
    s_branch pb_11
gs_12:
    s_cmp_lg_u32 s32, 0
    s_cbranch_scc1 gb_13
    s_mov_b32 s57, 0
    s_mov_b64 exec, 15
gl_14:
    buffer_load_dword v109, v110, s[16:19], 0 offen sc1
    s_add_u32 s57, s57, 1
    s_waitcnt vmcnt(0)
    v_cmp_lt_u32 vcc, v109, v111
    s_cmp_lt_u32 s57, 20000
    s_cselect_b64 vcc, vcc, 0
    s_cbranch_vccnz gl_14
    s_mov_b64 exec, -1
    s_branch gb_13
ps_15:
    s_waitcnt vmcnt(9) lgkmcnt(0)
    s_atomic_add s58, s[82:83], s71 offset:16388
    s_mov_b32 s71, -1
    s_cmp_ge_u32 s62, 8
    s_cbranch_scc1 pb_16
    s_atomic_umax s62, s[82:83], s72 offset:4 glc
    s_mov_b32 s57, 0
pl_41:
    s_waitcnt lgkmcnt(0)
    s_cmp_ge_u32 s62, 8
    s_cbranch_scc1 pb_16
    s_atomic_umax s62, s[82:83], s72 offset:4 glc
    s_add_u32 s57, s57, 1
    s_cmp_lt_u32 s57, 20000
    s_cbranch_scc1 pl_41
    s_waitcnt lgkmcnt(0)
    s_branch pb_16
gs_18:
    s_mov_b32 s57, 0
    s_mov_b64 exec, 16
gl_20:
    buffer_load_dword v109, v110, s[16:19], 0 offen sc1
    s_add_u32 s57, s57, 1
    s_waitcnt vmcnt(0)
    v_cmp_lt_u32 vcc, v109, v111
    s_cmp_lt_u32 s57, 20000
    s_cselect_b64 vcc, vcc, 0
    s_cbranch_vccnz gl_20
    s_mov_b64 exec, -1
    s_branch gb_19
gs_28:
    s_mov_b32 s57, 0
    s_mov_b64 exec, 32
gl_30:
    buffer_load_dword v27, v26, s[16:19], 0 offen sc1
    s_add_u32 s57, s57, 1
    s_waitcnt vmcnt(0)
    v_cmp_lt_u32 vcc, v27, v7
    s_cmp_lt_u32 s57, 20000
    s_cselect_b64 vcc, vcc, 0
    s_cbranch_vccnz gl_30
    s_mov_b64 exec, -1
    s_branch gb_29
ps_31:
    s_mov_b32 s57, 0
pl_42:
    s_waitcnt lgkmcnt(0)
    s_cmp_ge_u32 s65, 8
    s_cbranch_scc1 pb_32
    s_atomic_umax s65, s[82:83], s72 offset:8 glc
    s_add_u32 s57, s57, 1
    s_cmp_lt_u32 s57, 20000
    s_cbranch_scc1 pl_42
    s_waitcnt lgkmcnt(0)
    s_branch pb_32
ps_33:
    s_mov_b32 s57, 0
pl_43:
    s_waitcnt lgkmcnt(0)
    s_cmp_ge_u32 s66, 8
    s_cbranch_scc1 pb_34
    s_atomic_umax s66, s[82:83], s72 offset:16392 glc
    s_add_u32 s57, s57, 1
    s_cmp_lt_u32 s57, 20000
    s_cbranch_scc1 pl_43
    s_waitcnt lgkmcnt(0)
    s_branch pb_34
ps_35:
    s_mov_b32 s57, 0
pl_44:
    s_waitcnt lgkmcnt(0)
    s_cmp_ge_u32 s67, 8
    s_cbranch_scc1 pb_36
    s_atomic_umax s67, s[82:83], s72 offset:32776 glc
    s_add_u32 s57, s57, 1
    s_cmp_lt_u32 s57, 20000
    s_cbranch_scc1 pl_44
    s_waitcnt lgkmcnt(0)
    s_branch pb_36
ps_37:
    s_mov_b32 s57, 0
pl_45:
    s_waitcnt lgkmcnt(0)
    s_cmp_ge_u32 s68, 8
    s_cbranch_scc1 pb_38
    s_atomic_umax s68, s[82:83], s72 offset:49160 glc
    s_add_u32 s57, s57, 1
    s_cmp_lt_u32 s57, 20000
    s_cbranch_scc1 pl_45
    s_waitcnt lgkmcnt(0)
    s_branch pb_38
L_fin:
.section .rodata,"a"
.p2align 6
.amdhsa_kernel sequential_preLN__sliding_block__glu_gated_reglu__prompt_kernel
  .amdhsa_next_free_vgpr 512
  .amdhsa_next_free_sgpr 102
  .amdhsa_accum_offset 256
  .amdhsa_group_segment_fixed_size 0
  .amdhsa_kernarg_size 80
  .amdhsa_user_sgpr_count 2
  .amdhsa_user_sgpr_kernarg_segment_ptr 1
  .amdhsa_system_sgpr_workgroup_id_x 1
  .amdhsa_float_denorm_mode_32 3
  .amdhsa_float_denorm_mode_16_64 3
.end_amdhsa_kernel
```
